```python
import torch

def _softmax(x, axis=-1):
    return torch.softmax(x, dim=axis)
def _gelu(x):
    return torch.nn.functional.gelu(x, approximate="tanh")
def _silu(x):
    return torch.nn.functional.silu(x)
def _sigmoid(x):
    return torch.sigmoid(x)
def _layernorm(x, axis=-1, eps=1e-5):
    m = x.mean(dim=axis, keepdim=True)
    v = x.var(dim=axis, keepdim=True, unbiased=False)
    return (x - m) / torch.sqrt(v + eps)
def _scatter_add(tgt, idx, src, axis=0):
    return tgt.clone().index_add_(axis, idx, src)
def _segment_sum(src, seg, n):
    out = torch.zeros((n,) + src.shape[1:], dtype=src.dtype)
    return out.index_add_(0, seg, src)
def _pad(x, pw):
    flat = tuple(v for pair in reversed(pw) for v in pair)
    return torch.nn.functional.pad(x, flat)

kernel_name = 'concat_heads__mha_block_cached__gqa_block_cached__near_ridge'

def setup_inputs():

    _w = (lambda a: (lambda t: t.to(torch.bfloat16) if t.is_floating_point() else t)(torch.as_tensor(a)))
    def _A_setup():
        B, Sq, D = 8, 144, 640
        H, Sk, Dh = 32, 512, 128
        return {
            "x": _w((lambda *s: torch.randn(*s, dtype=torch.bfloat16) * 0.8)(B, Sq, D)),
            "k_cache": _w((lambda *s: torch.randn(*s, dtype=torch.bfloat16) * 0.8)(B, H, Sk, Dh)),
            "v_cache": _w((lambda *s: torch.randn(*s, dtype=torch.bfloat16) * 0.05)(B, H, Sk, Dh)),
            "wq": _w((lambda *s: torch.randn(*s, dtype=torch.bfloat16) * 0.8)(D, H * Dh) * (D ** -0.5)),
            "wo": _w((lambda *s: torch.randn(*s, dtype=torch.bfloat16) * 0.05)(H * Dh, D) * ((H * Dh) ** -0.5)),
        }
    _A_in = _A_setup()

    def _B_setup():
        B, Sq, D = 8, 144, 640
        Hq, Hkv, Sk, Dh = 32, 32, 512, 128
        assert Hq % Hkv == 0, (Hq, Hkv)
        return {
            "x": _w((lambda *s: torch.randn(*s, dtype=torch.bfloat16) * 0.8)(B, Sq, D)),
            "k_cache": _w((lambda *s: torch.randn(*s, dtype=torch.bfloat16) * 0.8)(B, Hkv, Sk, Dh)),
            "v_cache": _w((lambda *s: torch.randn(*s, dtype=torch.bfloat16) * 0.05)(B, Hkv, Sk, Dh)),
            "wq": _w((lambda *s: torch.randn(*s, dtype=torch.bfloat16) * 0.8)(D, Hq * Dh) * (D ** -0.5)),
            "wo": _w((lambda *s: torch.randn(*s, dtype=torch.bfloat16) * 0.05)(Hq * Dh, D) * ((Hq * Dh) ** -0.5)),
        }
    _B_in = _B_setup()

    return {
        "A_x": _A_in["x"],
        "A_k_cache": _A_in["k_cache"],
        "A_v_cache": _A_in["v_cache"],
        "A_wq": _A_in["wq"],
        "A_wo": _A_in["wo"],
        "B_x": _B_in["x"],
        "B_k_cache": _B_in["k_cache"],
        "B_v_cache": _B_in["v_cache"],
        "B_wq": _B_in["wq"],
        "B_wo": _B_in["wo"],
    }

def reference(A_x, A_k_cache, A_v_cache, A_wq, A_wo, B_x, B_k_cache, B_v_cache, B_wq, B_wo):
    def _A_ref(x, k_cache, v_cache, wq, wo):
        B, Sq, D = x.shape
        H, Dh = 32, 128
        q = (lambda x, *d: x.permute(*d))((x @ wq).reshape(B, Sq, H, Dh), 0, 2, 1, 3)
        scores = torch.einsum("bhqd,bhkd->bhqk", q, k_cache) * (Dh ** -0.5)
        p = _softmax(scores, axis=-1)
        o = torch.einsum("bhqk,bhkd->bhqd", p, v_cache)
        return (lambda x, *d: x.permute(*d))(o, 0, 2, 1, 3).reshape(B, Sq, H * Dh) @ wo

    def _B_ref(x, k_cache, v_cache, wq, wo):
        B, Sq, D = x.shape
        Hq, Dh = 32, 128
        Hkv = k_cache.shape[1]
        rep = Hq // Hkv
        q = (lambda x, *d: x.permute(*d))((x @ wq).reshape(B, Sq, Hq, Dh), 0, 2, 1, 3)
        k = (lambda x, n, axis: torch.repeat_interleave(x, n, dim=axis))(k_cache, rep, axis=1)
        v = (lambda x, n, axis: torch.repeat_interleave(x, n, dim=axis))(v_cache, rep, axis=1)
        scores = torch.einsum("bhqd,bhkd->bhqk", q, k) * (Dh ** -0.5)
        p = _softmax(scores, axis=-1)
        o = torch.einsum("bhqk,bhkd->bhqd", p, v)
        return (lambda x, *d: x.permute(*d))(o, 0, 2, 1, 3).reshape(B, Sq, Hq * Dh) @ wo

    a = _A_ref(A_x, A_k_cache, A_v_cache, A_wq, A_wo)
    b = _B_ref(B_x, B_k_cache, B_v_cache, B_wq, B_wo)
    return torch.concatenate([a, b], axis=-1)
```

```asm
; @launch kernel=attn_kernel grid=(256,1,1) block=(576,1,1) lds=153600
; @launch kernel=oproj_kernel grid=(240,1,1) block=(256,1,1) lds=98304
.amdgcn_target "amdgcn-amd-amdhsa--gfx950"
.text
.globl attn_kernel
.type attn_kernel,@function
.globl oproj_kernel
.type oproj_kernel,@function
.p2align 8
attn_kernel:
s_cmp_ge_u32 s2, 256
s_cbranch_scc1 L_attn_end
s_load_dwordx16 s[16:31], s[0:1], 0
s_load_dwordx8 s[32:39], s[0:1], 64
s_load_dwordx2 s[40:41], s[0:1], 96
s_and_b32 s7, s2, 7
s_lshr_b32 s8, s2, 3
s_lshr_b32 s4, s7, 2
s_and_b32 s7, s7, 3
s_lshl_b32 s7, s7, 2
s_and_b32 s9, s8, 3
s_add_u32 s5, s7, s9
s_lshr_b32 s6, s8, 2
s_mov_b32 s10, 0x3e0293ee
v_and_b32 v1, 63, v0
v_and_b32 v2, 15, v0
v_lshrrev_b32 v3, 4, v1
v_lshrrev_b32 v4, 6, v0
s_nop 0
v_readfirstlane_b32 s3, v4
s_waitcnt lgkmcnt(0)
s_cmp_eq_u32 s4, 0
s_cselect_b64 s[64:65], s[16:17], s[26:27]
s_cselect_b64 s[66:67], s[18:19], s[28:29]
s_cselect_b64 s[68:69], s[20:21], s[30:31]
s_cselect_b64 s[70:71], s[22:23], s[32:33]
s_mul_i32 s7, s6, 184320
s_add_u32 s8, s64, s7
s_addc_u32 s9, s65, 0
s_mov_b32 s44, s8
s_and_b32 s45, s9, 0xffff
s_mov_b32 s46, 184320
s_mov_b32 s47, 0x20000
s_lshl_b32 s7, s6, 5
s_lshl_b32 s8, s5, 1
s_add_u32 s7, s7, s8
s_lshl_b32 s7, s7, 17
s_add_u32 s8, s66, s7
s_addc_u32 s9, s67, 0
s_mov_b32 s48, s8
s_and_b32 s49, s9, 0xffff
s_mov_b32 s50, 262144
s_mov_b32 s51, 0x20000
s_add_u32 s8, s68, s7
s_addc_u32 s9, s69, 0
s_mov_b32 s52, s8
s_and_b32 s53, s9, 0xffff
s_mov_b32 s54, 262144
s_mov_b32 s55, 0x20000
s_lshl_b32 s7, s5, 9
s_add_u32 s8, s70, s7
s_addc_u32 s9, s71, 0
s_sub_u32 s13, 5242880, s7
s_mov_b32 s56, s8
s_and_b32 s57, s9, 0xffff
s_mov_b32 s58, s13
s_mov_b32 s59, 0x20000
s_mul_i32 s7, s4, 9437184
s_add_u32 s8, s40, s7
s_addc_u32 s9, s41, 0
s_mov_b32 s60, s8
s_and_b32 s61, s9, 0xffff
s_mov_b32 s62, 9437184
s_mov_b32 s63, 0x20000
s_mul_i32 s7, s6, 1152
s_lshl_b32 s8, s5, 3
s_add_u32 s7, s7, s8
s_lshl_b32 s72, s7, 10
v_lshlrev_b32 v5, 4, v1
v_lshlrev_b32 v6, 3, v1
s_min_u32 s74, s3, 7
s_mul_i32 s81, s3, 20480
v_lshrrev_b32 v14, 3, v1
v_and_b32 v15, 7, v1
v_xor_b32 v15, v15, v14
v_mul_u32_u24 v14, 1280, v14
v_lshl_add_u32 v14, v15, 4, v14
v_add_u32 v7, s81, v14
v_lshrrev_b32 v14, 3, v1
v_lshlrev_b32 v14, 5, v14
v_and_b32 v15, 1, v1
v_lshl_add_u32 v14, v15, 4, v14
v_lshrrev_b32 v15, 1, v1
v_and_b32 v15, 3, v15
v_lshl_add_u32 v8, v15, 13, v14
v_xor_b32 v9, 32, v8
v_lshl_add_u32 v12, v15, 8, v14
v_xor_b32 v13, 32, v12
v_lshrrev_b32 v14, 5, v1
v_lshrrev_b32 v15, 1, v1
v_and_b32 v15, 15, v15
v_xor_b32 v15, v15, v14
v_lshlrev_b32 v15, 5, v15
v_lshl_add_u32 v15, v14, 13, v15
v_and_b32 v14, 1, v1
v_lshl_add_u32 v15, v14, 4, v15
s_lshr_b32 s81, s74, 1
s_and_b32 s81, s81, 1
s_lshl_b32 s81, s81, 7
v_xor_b32 v8, s81, v15
v_xor_b32 v9, 64, v8
v_xor_b32 v14, v2, v3
v_lshlrev_b32 v14, 4, v14
v_lshl_add_u32 v14, v3, 8, v14
s_and_b32 s81, s74, 1
s_lshl_b32 s81, s81, 7
v_xor_b32 v10, s81, v14
v_xor_b32 v11, 64, v10
v_lshrrev_b32 v14, 2, v2
v_lshlrev_b32 v14, 5, v14
v_and_b32 v15, 3, v2
v_lshl_add_u32 v14, v15, 3, v14
v_lshl_add_u32 v14, v3, 10, v14
v_and_b32 v15, 1, v3
v_lshlrev_b32 v15, 7, v15
v_add_u32 v154, v14, v15
v_sub_u32 v155, v14, v15
v_xor_b32 v14, v3, v2
v_lshlrev_b32 v14, 4, v14
v_lshl_add_u32 v160, v2, 8, v14
s_lshl_b32 s81, s74, 10
s_add_u32 s81, s81, 65536
v_lshrrev_b32 v14, 1, v3
v_lshl_add_u32 v14, v14, 4, v2
v_lshlrev_b32 v14, 4, v14
v_and_b32 v15, 1, v3
v_lshl_add_u32 v14, v15, 3, v14
v_add_u32 v164, s81, v14
v_add_u32 v166, 65536, v164
s_lshl_b32 s81, s3, 13
s_add_u32 s81, s81, 65536
v_add_u32 v165, s81, v5
s_mul_i32 s7, s6, 3
s_and_b32 s8, s5, 3
s_mul_i32 s8, s8, 5
s_add_u32 s7, s7, s8
s_mul_i32 s8, s7, 205
s_lshr_b32 s8, s8, 11
s_mul_i32 s8, s8, 10
s_sub_u32 s7, s7, s8
s_lshl_b32 s92, s7, 1
s_lshl_b32 s75, s74, 15
s_lshl_b32 s76, s74, 11
s_lshl_b32 s77, s3, 11
v_lshrrev_b32 v14, 2, v2
v_and_b32 v15, 1, v3
v_lshl_add_u32 v15, v15, 2, v14
s_lshl_b32 s81, s74, 1
v_xor_b32 v15, s81, v15
v_lshlrev_b32 v15, 5, v15
v_lshl_add_u32 v15, v3, 12, v15
v_lshrrev_b32 v153, 1, v14
v_lshl_add_u32 v15, v153, 10, v15
v_and_b32 v153, 1, v14
v_lshl_add_u32 v15, v153, 9, v15
v_and_b32 v153, 3, v2
v_lshl_add_u32 v144, v153, 3, v15
v_xor_b32 v145, 32, v144
v_add_u32 v146, 65536, v144
v_add_u32 v147, 65536, v145
v_and_b32 v14, 7, v2
v_xor_b32 v15, v3, v14
v_lshlrev_b32 v15, 4, v15
v_lshl_add_u32 v15, v14, 7, v15
v_lshrrev_b32 v14, 3, v2
v_lshl_add_u32 v15, v14, 10, v15
v_add_u32 v150, 98304, v15
v_xor_b32 v151, 64, v150
s_add_u32 s93, s92, 0
s_sub_u32 s82, s93, 20
s_cmp_ge_u32 s93, 20
s_cselect_b32 s93, s82, s93
s_lshl_b32 s81, s93, 18
s_add_u32 s81, s81, s75
s_add_u32 m0, s76, 65536
s_add_u32 s82, s81, 0
buffer_load_dwordx4 v8, s[56:59], s82 offen lds
s_add_u32 m0, s76, 66560
s_add_u32 s82, s81, 16384
buffer_load_dwordx4 v9, s[56:59], s82 offen lds
s_add_u32 s93, s92, 0
s_sub_u32 s82, s93, 20
s_cmp_ge_u32 s93, 20
s_cselect_b32 s93, s82, s93
s_lshl_b32 s81, s93, 6
s_add_u32 m0, s77, 98304
s_add_u32 s82, s81, 0
buffer_load_dwordx4 v7, s[44:47], s82 offen lds
s_add_u32 m0, s77, 99328
s_add_u32 s82, s81, 10240
buffer_load_dwordx4 v7, s[44:47], s82 offen lds
s_barrier
s_add_u32 s93, s92, 1
s_sub_u32 s82, s93, 20
s_cmp_ge_u32 s93, 20
s_cselect_b32 s93, s82, s93
s_lshl_b32 s81, s93, 18
s_add_u32 s81, s81, s75
s_add_u32 m0, s76, 81920
s_add_u32 s82, s81, 0
buffer_load_dwordx4 v8, s[56:59], s82 offen lds
s_add_u32 m0, s76, 82944
s_add_u32 s82, s81, 16384
buffer_load_dwordx4 v9, s[56:59], s82 offen lds
s_barrier
s_add_u32 s93, s92, 2
s_sub_u32 s82, s93, 20
s_cmp_ge_u32 s93, 20
s_cselect_b32 s93, s82, s93
s_lshl_b32 s81, s93, 18
s_add_u32 s81, s81, s75
s_add_u32 m0, s76, 0
s_add_u32 s82, s81, 0
buffer_load_dwordx4 v8, s[56:59], s82 offen lds
s_add_u32 m0, s76, 1024
s_add_u32 s82, s81, 16384
buffer_load_dwordx4 v9, s[56:59], s82 offen lds
s_add_u32 s93, s92, 2
s_sub_u32 s82, s93, 20
s_cmp_ge_u32 s93, 20
s_cselect_b32 s93, s82, s93
s_lshl_b32 s81, s93, 6
s_add_u32 m0, s77, 116736
s_add_u32 s82, s81, 0
buffer_load_dwordx4 v7, s[44:47], s82 offen lds
s_add_u32 m0, s77, 117760
s_add_u32 s82, s81, 10240
buffer_load_dwordx4 v7, s[44:47], s82 offen lds
s_add_u32 s93, s92, 3
s_sub_u32 s82, s93, 20
s_cmp_ge_u32 s93, 20
s_cselect_b32 s93, s82, s93
s_lshl_b32 s81, s93, 18
s_add_u32 s81, s81, s75
s_add_u32 m0, s76, 16384
s_add_u32 s82, s81, 0
buffer_load_dwordx4 v8, s[56:59], s82 offen lds
s_add_u32 m0, s76, 17408
s_add_u32 s82, s81, 16384
buffer_load_dwordx4 v9, s[56:59], s82 offen lds
s_add_u32 s93, s92, 4
s_sub_u32 s82, s93, 20
s_cmp_ge_u32 s93, 20
s_cselect_b32 s93, s82, s93
s_lshl_b32 s81, s93, 18
s_add_u32 s81, s81, s75
s_add_u32 m0, s76, 32768
s_add_u32 s82, s81, 0
buffer_load_dwordx4 v8, s[56:59], s82 offen lds
s_add_u32 m0, s76, 33792
s_add_u32 s82, s81, 16384
buffer_load_dwordx4 v9, s[56:59], s82 offen lds
s_waitcnt vmcnt(10)
s_barrier
s_cmp_ge_u32 s3, 8
s_cbranch_scc1 L_q8a1
ds_read_b64_tr_b16 v[16:17], v146 offset:0
ds_read_b64_tr_b16 v[18:19], v146 offset:2048
ds_read_b64_tr_b16 v[20:21], v147 offset:0
ds_read_b64_tr_b16 v[22:23], v147 offset:2048
ds_read_b128 v[120:123], v150
ds_read_b128 v[124:127], v150 offset:2048
ds_read_b128 v[128:131], v150 offset:4096
ds_read_b128 v[132:135], v150 offset:6144
ds_read_b128 v[136:139], v150 offset:8192
L_q8a1:
s_waitcnt vmcnt(8)
s_barrier
s_add_u32 s93, s92, 5
s_sub_u32 s82, s93, 20
s_cmp_ge_u32 s93, 20
s_cselect_b32 s93, s82, s93
s_lshl_b32 s81, s93, 18
s_add_u32 s81, s81, s75
s_add_u32 m0, s76, 49152
s_add_u32 s82, s81, 0
buffer_load_dwordx4 v8, s[56:59], s82 offen lds
s_add_u32 m0, s76, 50176
s_add_u32 s82, s81, 16384
buffer_load_dwordx4 v9, s[56:59], s82 offen lds
s_add_u32 s93, s92, 4
s_sub_u32 s82, s93, 20
s_cmp_ge_u32 s93, 20
s_cselect_b32 s93, s82, s93
s_lshl_b32 s81, s93, 6
s_add_u32 m0, s77, 135168
s_add_u32 s82, s81, 0
buffer_load_dwordx4 v7, s[44:47], s82 offen lds
s_add_u32 m0, s77, 136192
s_add_u32 s82, s81, 10240
buffer_load_dwordx4 v7, s[44:47], s82 offen lds
s_cmp_ge_u32 s3, 8
s_cbranch_scc1 L_q82
ds_read_b64_tr_b16 v[24:25], v146 offset:16384
ds_read_b64_tr_b16 v[26:27], v146 offset:18432
ds_read_b64_tr_b16 v[28:29], v147 offset:16384
ds_read_b64_tr_b16 v[30:31], v147 offset:18432
ds_read_b128 v[140:143], v150 offset:10240
s_waitcnt lgkmcnt(9)
v_mfma_f32_16x16x32_bf16 v[48:51], v[16:19], v[120:123], 0
v_mfma_f32_16x16x32_bf16 v[84:87], v[20:23], v[120:123], 0
ds_read_b128 v[120:123], v150 offset:12288
s_waitcnt lgkmcnt(9)
v_mfma_f32_16x16x32_bf16 v[52:55], v[16:19], v[124:127], 0
v_mfma_f32_16x16x32_bf16 v[88:91], v[20:23], v[124:127], 0
ds_read_b128 v[124:127], v150 offset:14336
s_waitcnt lgkmcnt(9)
v_mfma_f32_16x16x32_bf16 v[56:59], v[16:19], v[128:131], 0
v_mfma_f32_16x16x32_bf16 v[92:95], v[20:23], v[128:131], 0
ds_read_b128 v[128:131], v150 offset:16384
s_waitcnt lgkmcnt(9)
v_mfma_f32_16x16x32_bf16 v[60:63], v[16:19], v[132:135], 0
v_mfma_f32_16x16x32_bf16 v[96:99], v[20:23], v[132:135], 0
ds_read_b128 v[132:135], v151
s_waitcnt lgkmcnt(9)
v_mfma_f32_16x16x32_bf16 v[64:67], v[16:19], v[136:139], 0
v_mfma_f32_16x16x32_bf16 v[100:103], v[20:23], v[136:139], 0
ds_read_b128 v[136:139], v151 offset:2048
s_waitcnt lgkmcnt(5)
v_mfma_f32_16x16x32_bf16 v[68:71], v[16:19], v[140:143], 0
v_mfma_f32_16x16x32_bf16 v[104:107], v[20:23], v[140:143], 0
ds_read_b128 v[140:143], v151 offset:4096
s_waitcnt lgkmcnt(5)
v_mfma_f32_16x16x32_bf16 v[72:75], v[16:19], v[120:123], 0
v_mfma_f32_16x16x32_bf16 v[108:111], v[20:23], v[120:123], 0
ds_read_b128 v[120:123], v151 offset:6144
s_waitcnt lgkmcnt(5)
v_mfma_f32_16x16x32_bf16 v[76:79], v[16:19], v[124:127], 0
v_mfma_f32_16x16x32_bf16 v[112:115], v[20:23], v[124:127], 0
ds_read_b128 v[124:127], v151 offset:8192
s_waitcnt lgkmcnt(5)
v_mfma_f32_16x16x32_bf16 v[80:83], v[16:19], v[128:131], 0
v_mfma_f32_16x16x32_bf16 v[116:119], v[20:23], v[128:131], 0
L_q82:
s_waitcnt vmcnt(8)
s_barrier
s_add_u32 s93, s92, 6
s_sub_u32 s82, s93, 20
s_cmp_ge_u32 s93, 20
s_cselect_b32 s93, s82, s93
s_lshl_b32 s81, s93, 18
s_add_u32 s81, s81, s75
s_add_u32 m0, s76, 65536
s_add_u32 s82, s81, 0
buffer_load_dwordx4 v8, s[56:59], s82 offen lds
s_add_u32 m0, s76, 66560
s_add_u32 s82, s81, 16384
buffer_load_dwordx4 v9, s[56:59], s82 offen lds
s_cmp_ge_u32 s3, 8
s_cbranch_scc1 L_q83
ds_read_b64_tr_b16 v[16:17], v144 offset:0
ds_read_b64_tr_b16 v[18:19], v144 offset:2048
ds_read_b64_tr_b16 v[20:21], v145 offset:0
ds_read_b64_tr_b16 v[22:23], v145 offset:2048
ds_read_b128 v[128:131], v151 offset:10240
s_waitcnt lgkmcnt(9)
v_mfma_f32_16x16x32_bf16 v[48:51], v[24:27], v[132:135], v[48:51]
v_mfma_f32_16x16x32_bf16 v[84:87], v[28:31], v[132:135], v[84:87]
ds_read_b128 v[132:135], v151 offset:12288
s_waitcnt lgkmcnt(9)
v_mfma_f32_16x16x32_bf16 v[52:55], v[24:27], v[136:139], v[52:55]
v_mfma_f32_16x16x32_bf16 v[88:91], v[28:31], v[136:139], v[88:91]
ds_read_b128 v[136:139], v151 offset:14336
s_waitcnt lgkmcnt(9)
v_mfma_f32_16x16x32_bf16 v[56:59], v[24:27], v[140:143], v[56:59]
v_mfma_f32_16x16x32_bf16 v[92:95], v[28:31], v[140:143], v[92:95]
ds_read_b128 v[140:143], v151 offset:16384
s_waitcnt lgkmcnt(9)
v_mfma_f32_16x16x32_bf16 v[60:63], v[24:27], v[120:123], v[60:63]
v_mfma_f32_16x16x32_bf16 v[96:99], v[28:31], v[120:123], v[96:99]
ds_read_b128 v[120:123], v150 offset:18432
s_waitcnt lgkmcnt(9)
v_mfma_f32_16x16x32_bf16 v[64:67], v[24:27], v[124:127], v[64:67]
v_mfma_f32_16x16x32_bf16 v[100:103], v[28:31], v[124:127], v[100:103]
ds_read_b128 v[124:127], v150 offset:20480
s_waitcnt lgkmcnt(5)
v_mfma_f32_16x16x32_bf16 v[68:71], v[24:27], v[128:131], v[68:71]
v_mfma_f32_16x16x32_bf16 v[104:107], v[28:31], v[128:131], v[104:107]
ds_read_b128 v[128:131], v150 offset:22528
s_waitcnt lgkmcnt(5)
v_mfma_f32_16x16x32_bf16 v[72:75], v[24:27], v[132:135], v[72:75]
v_mfma_f32_16x16x32_bf16 v[108:111], v[28:31], v[132:135], v[108:111]
ds_read_b128 v[132:135], v150 offset:24576
s_waitcnt lgkmcnt(5)
v_mfma_f32_16x16x32_bf16 v[76:79], v[24:27], v[136:139], v[76:79]
v_mfma_f32_16x16x32_bf16 v[112:115], v[28:31], v[136:139], v[112:115]
ds_read_b128 v[136:139], v150 offset:26624
s_waitcnt lgkmcnt(5)
v_mfma_f32_16x16x32_bf16 v[80:83], v[24:27], v[140:143], v[80:83]
v_mfma_f32_16x16x32_bf16 v[116:119], v[28:31], v[140:143], v[116:119]
L_q83:
s_waitcnt vmcnt(8)
s_barrier
s_add_u32 s93, s92, 7
s_sub_u32 s82, s93, 20
s_cmp_ge_u32 s93, 20
s_cselect_b32 s93, s82, s93
s_lshl_b32 s81, s93, 18
s_add_u32 s81, s81, s75
s_add_u32 m0, s76, 81920
s_add_u32 s82, s81, 0
buffer_load_dwordx4 v8, s[56:59], s82 offen lds
s_add_u32 m0, s76, 82944
s_add_u32 s82, s81, 16384
buffer_load_dwordx4 v9, s[56:59], s82 offen lds
s_add_u32 s93, s92, 6
s_sub_u32 s82, s93, 20
s_cmp_ge_u32 s93, 20
s_cselect_b32 s93, s82, s93
s_lshl_b32 s81, s93, 6
s_add_u32 m0, s77, 98304
s_add_u32 s82, s81, 0
buffer_load_dwordx4 v7, s[44:47], s82 offen lds
s_add_u32 m0, s77, 99328
s_add_u32 s82, s81, 10240
buffer_load_dwordx4 v7, s[44:47], s82 offen lds
s_cmp_ge_u32 s3, 8
s_cbranch_scc1 L_q84
ds_read_b64_tr_b16 v[24:25], v144 offset:16384
ds_read_b64_tr_b16 v[26:27], v144 offset:18432
ds_read_b64_tr_b16 v[28:29], v145 offset:16384
ds_read_b64_tr_b16 v[30:31], v145 offset:18432
ds_read_b128 v[140:143], v150 offset:28672
s_waitcnt lgkmcnt(9)
v_mfma_f32_16x16x32_bf16 v[48:51], v[16:19], v[120:123], v[48:51]
v_mfma_f32_16x16x32_bf16 v[84:87], v[20:23], v[120:123], v[84:87]
ds_read_b128 v[120:123], v150 offset:30720
s_waitcnt lgkmcnt(9)
v_mfma_f32_16x16x32_bf16 v[52:55], v[16:19], v[124:127], v[52:55]
v_mfma_f32_16x16x32_bf16 v[88:91], v[20:23], v[124:127], v[88:91]
ds_read_b128 v[124:127], v150 offset:32768
s_waitcnt lgkmcnt(9)
v_mfma_f32_16x16x32_bf16 v[56:59], v[16:19], v[128:131], v[56:59]
v_mfma_f32_16x16x32_bf16 v[92:95], v[20:23], v[128:131], v[92:95]
ds_read_b128 v[128:131], v150 offset:34816
s_waitcnt lgkmcnt(9)
v_mfma_f32_16x16x32_bf16 v[60:63], v[16:19], v[132:135], v[60:63]
v_mfma_f32_16x16x32_bf16 v[96:99], v[20:23], v[132:135], v[96:99]
ds_read_b128 v[132:135], v151 offset:18432
s_waitcnt lgkmcnt(9)
v_mfma_f32_16x16x32_bf16 v[64:67], v[16:19], v[136:139], v[64:67]
v_mfma_f32_16x16x32_bf16 v[100:103], v[20:23], v[136:139], v[100:103]
ds_read_b128 v[136:139], v151 offset:20480
s_waitcnt lgkmcnt(5)
v_mfma_f32_16x16x32_bf16 v[68:71], v[16:19], v[140:143], v[68:71]
v_mfma_f32_16x16x32_bf16 v[104:107], v[20:23], v[140:143], v[104:107]
ds_read_b128 v[140:143], v151 offset:22528
s_waitcnt lgkmcnt(5)
v_mfma_f32_16x16x32_bf16 v[72:75], v[16:19], v[120:123], v[72:75]
v_mfma_f32_16x16x32_bf16 v[108:111], v[20:23], v[120:123], v[108:111]
ds_read_b128 v[120:123], v151 offset:24576
s_waitcnt lgkmcnt(5)
v_mfma_f32_16x16x32_bf16 v[76:79], v[16:19], v[124:127], v[76:79]
v_mfma_f32_16x16x32_bf16 v[112:115], v[20:23], v[124:127], v[112:115]
ds_read_b128 v[124:127], v151 offset:26624
s_waitcnt lgkmcnt(5)
v_mfma_f32_16x16x32_bf16 v[80:83], v[16:19], v[128:131], v[80:83]
v_mfma_f32_16x16x32_bf16 v[116:119], v[20:23], v[128:131], v[116:119]
L_q84:
s_waitcnt vmcnt(6)
s_barrier
s_add_u32 s93, s92, 8
s_sub_u32 s82, s93, 20
s_cmp_ge_u32 s93, 20
s_cselect_b32 s93, s82, s93
s_lshl_b32 s81, s93, 18
s_add_u32 s81, s81, s75
s_add_u32 m0, s76, 0
s_add_u32 s82, s81, 0
buffer_load_dwordx4 v8, s[56:59], s82 offen lds
s_add_u32 m0, s76, 1024
s_add_u32 s82, s81, 16384
buffer_load_dwordx4 v9, s[56:59], s82 offen lds
s_cmp_ge_u32 s3, 8
s_cbranch_scc1 L_q85
ds_read_b64_tr_b16 v[16:17], v144 offset:32768
ds_read_b64_tr_b16 v[18:19], v144 offset:34816
ds_read_b64_tr_b16 v[20:21], v145 offset:32768
ds_read_b64_tr_b16 v[22:23], v145 offset:34816
ds_read_b128 v[128:131], v151 offset:28672
s_waitcnt lgkmcnt(9)
v_mfma_f32_16x16x32_bf16 v[48:51], v[24:27], v[132:135], v[48:51]
v_mfma_f32_16x16x32_bf16 v[84:87], v[28:31], v[132:135], v[84:87]
ds_read_b128 v[132:135], v151 offset:30720
s_waitcnt lgkmcnt(9)
v_mfma_f32_16x16x32_bf16 v[52:55], v[24:27], v[136:139], v[52:55]
v_mfma_f32_16x16x32_bf16 v[88:91], v[28:31], v[136:139], v[88:91]
ds_read_b128 v[136:139], v151 offset:32768
s_waitcnt lgkmcnt(9)
v_mfma_f32_16x16x32_bf16 v[56:59], v[24:27], v[140:143], v[56:59]
v_mfma_f32_16x16x32_bf16 v[92:95], v[28:31], v[140:143], v[92:95]
ds_read_b128 v[140:143], v151 offset:34816
s_waitcnt lgkmcnt(9)
v_mfma_f32_16x16x32_bf16 v[60:63], v[24:27], v[120:123], v[60:63]
v_mfma_f32_16x16x32_bf16 v[96:99], v[28:31], v[120:123], v[96:99]
ds_read_b128 v[120:123], v150 offset:36864
s_waitcnt lgkmcnt(9)
v_mfma_f32_16x16x32_bf16 v[64:67], v[24:27], v[124:127], v[64:67]
v_mfma_f32_16x16x32_bf16 v[100:103], v[28:31], v[124:127], v[100:103]
ds_read_b128 v[124:127], v150 offset:38912
s_waitcnt lgkmcnt(5)
v_mfma_f32_16x16x32_bf16 v[68:71], v[24:27], v[128:131], v[68:71]
v_mfma_f32_16x16x32_bf16 v[104:107], v[28:31], v[128:131], v[104:107]
ds_read_b128 v[128:131], v150 offset:40960
s_waitcnt lgkmcnt(5)
v_mfma_f32_16x16x32_bf16 v[72:75], v[24:27], v[132:135], v[72:75]
v_mfma_f32_16x16x32_bf16 v[108:111], v[28:31], v[132:135], v[108:111]
ds_read_b128 v[132:135], v150 offset:43008
s_waitcnt lgkmcnt(5)
v_mfma_f32_16x16x32_bf16 v[76:79], v[24:27], v[136:139], v[76:79]
v_mfma_f32_16x16x32_bf16 v[112:115], v[28:31], v[136:139], v[112:115]
ds_read_b128 v[136:139], v150 offset:45056
s_waitcnt lgkmcnt(5)
v_mfma_f32_16x16x32_bf16 v[80:83], v[24:27], v[140:143], v[80:83]
v_mfma_f32_16x16x32_bf16 v[116:119], v[28:31], v[140:143], v[116:119]
L_q85:
s_waitcnt vmcnt(8)
s_barrier
s_add_u32 s93, s92, 9
s_sub_u32 s82, s93, 20
s_cmp_ge_u32 s93, 20
s_cselect_b32 s93, s82, s93
s_lshl_b32 s81, s93, 18
s_add_u32 s81, s81, s75
s_add_u32 m0, s76, 16384
s_add_u32 s82, s81, 0
buffer_load_dwordx4 v8, s[56:59], s82 offen lds
s_add_u32 m0, s76, 17408
s_add_u32 s82, s81, 16384
buffer_load_dwordx4 v9, s[56:59], s82 offen lds
s_add_u32 s93, s92, 8
s_sub_u32 s82, s93, 20
s_cmp_ge_u32 s93, 20
s_cselect_b32 s93, s82, s93
s_lshl_b32 s81, s93, 6
s_add_u32 m0, s77, 116736
s_add_u32 s82, s81, 0
buffer_load_dwordx4 v7, s[44:47], s82 offen lds
s_add_u32 m0, s77, 117760
s_add_u32 s82, s81, 10240
buffer_load_dwordx4 v7, s[44:47], s82 offen lds
s_cmp_ge_u32 s3, 8
s_cbranch_scc1 L_q86
ds_read_b64_tr_b16 v[24:25], v144 offset:49152
ds_read_b64_tr_b16 v[26:27], v144 offset:51200
ds_read_b64_tr_b16 v[28:29], v145 offset:49152
ds_read_b64_tr_b16 v[30:31], v145 offset:51200
ds_read_b128 v[140:143], v150 offset:47104
s_waitcnt lgkmcnt(9)
v_mfma_f32_16x16x32_bf16 v[48:51], v[16:19], v[120:123], v[48:51]
v_mfma_f32_16x16x32_bf16 v[84:87], v[20:23], v[120:123], v[84:87]
ds_read_b128 v[120:123], v150 offset:49152
s_waitcnt lgkmcnt(9)
v_mfma_f32_16x16x32_bf16 v[52:55], v[16:19], v[124:127], v[52:55]
v_mfma_f32_16x16x32_bf16 v[88:91], v[20:23], v[124:127], v[88:91]
ds_read_b128 v[124:127], v150 offset:51200
s_waitcnt lgkmcnt(9)
v_mfma_f32_16x16x32_bf16 v[56:59], v[16:19], v[128:131], v[56:59]
v_mfma_f32_16x16x32_bf16 v[92:95], v[20:23], v[128:131], v[92:95]
ds_read_b128 v[128:131], v150 offset:53248
s_waitcnt lgkmcnt(9)
v_mfma_f32_16x16x32_bf16 v[60:63], v[16:19], v[132:135], v[60:63]
v_mfma_f32_16x16x32_bf16 v[96:99], v[20:23], v[132:135], v[96:99]
ds_read_b128 v[132:135], v151 offset:36864
s_waitcnt lgkmcnt(9)
v_mfma_f32_16x16x32_bf16 v[64:67], v[16:19], v[136:139], v[64:67]
v_mfma_f32_16x16x32_bf16 v[100:103], v[20:23], v[136:139], v[100:103]
ds_read_b128 v[136:139], v151 offset:38912
s_waitcnt lgkmcnt(5)
v_mfma_f32_16x16x32_bf16 v[68:71], v[16:19], v[140:143], v[68:71]
v_mfma_f32_16x16x32_bf16 v[104:107], v[20:23], v[140:143], v[104:107]
ds_read_b128 v[140:143], v151 offset:40960
s_waitcnt lgkmcnt(5)
v_mfma_f32_16x16x32_bf16 v[72:75], v[16:19], v[120:123], v[72:75]
v_mfma_f32_16x16x32_bf16 v[108:111], v[20:23], v[120:123], v[108:111]
ds_read_b128 v[120:123], v151 offset:43008
s_waitcnt lgkmcnt(5)
v_mfma_f32_16x16x32_bf16 v[76:79], v[16:19], v[124:127], v[76:79]
v_mfma_f32_16x16x32_bf16 v[112:115], v[20:23], v[124:127], v[112:115]
ds_read_b128 v[124:127], v151 offset:45056
s_waitcnt lgkmcnt(5)
v_mfma_f32_16x16x32_bf16 v[80:83], v[16:19], v[128:131], v[80:83]
v_mfma_f32_16x16x32_bf16 v[116:119], v[20:23], v[128:131], v[116:119]
L_q86:
s_waitcnt vmcnt(6)
s_barrier
s_add_u32 s93, s92, 10
s_sub_u32 s82, s93, 20
s_cmp_ge_u32 s93, 20
s_cselect_b32 s93, s82, s93
s_lshl_b32 s81, s93, 18
s_add_u32 s81, s81, s75
s_add_u32 m0, s76, 32768
s_add_u32 s82, s81, 0
buffer_load_dwordx4 v8, s[56:59], s82 offen lds
s_add_u32 m0, s76, 33792
s_add_u32 s82, s81, 16384
buffer_load_dwordx4 v9, s[56:59], s82 offen lds
s_cmp_ge_u32 s3, 8
s_cbranch_scc1 L_q87
ds_read_b64_tr_b16 v[16:17], v146 offset:0
ds_read_b64_tr_b16 v[18:19], v146 offset:2048
ds_read_b64_tr_b16 v[20:21], v147 offset:0
ds_read_b64_tr_b16 v[22:23], v147 offset:2048
ds_read_b128 v[128:131], v151 offset:47104
s_waitcnt lgkmcnt(9)
v_mfma_f32_16x16x32_bf16 v[48:51], v[24:27], v[132:135], v[48:51]
v_mfma_f32_16x16x32_bf16 v[84:87], v[28:31], v[132:135], v[84:87]
ds_read_b128 v[132:135], v151 offset:49152
s_waitcnt lgkmcnt(9)
v_mfma_f32_16x16x32_bf16 v[52:55], v[24:27], v[136:139], v[52:55]
v_mfma_f32_16x16x32_bf16 v[88:91], v[28:31], v[136:139], v[88:91]
ds_read_b128 v[136:139], v151 offset:51200
s_waitcnt lgkmcnt(9)
v_mfma_f32_16x16x32_bf16 v[56:59], v[24:27], v[140:143], v[56:59]
v_mfma_f32_16x16x32_bf16 v[92:95], v[28:31], v[140:143], v[92:95]
ds_read_b128 v[140:143], v151 offset:53248
s_waitcnt lgkmcnt(9)
v_mfma_f32_16x16x32_bf16 v[60:63], v[24:27], v[120:123], v[60:63]
v_mfma_f32_16x16x32_bf16 v[96:99], v[28:31], v[120:123], v[96:99]
ds_read_b128 v[120:123], v150
s_waitcnt lgkmcnt(9)
v_mfma_f32_16x16x32_bf16 v[64:67], v[24:27], v[124:127], v[64:67]
v_mfma_f32_16x16x32_bf16 v[100:103], v[28:31], v[124:127], v[100:103]
ds_read_b128 v[124:127], v150 offset:2048
s_waitcnt lgkmcnt(5)
v_mfma_f32_16x16x32_bf16 v[68:71], v[24:27], v[128:131], v[68:71]
v_mfma_f32_16x16x32_bf16 v[104:107], v[28:31], v[128:131], v[104:107]
ds_read_b128 v[128:131], v150 offset:4096
s_waitcnt lgkmcnt(5)
v_mfma_f32_16x16x32_bf16 v[72:75], v[24:27], v[132:135], v[72:75]
v_mfma_f32_16x16x32_bf16 v[108:111], v[28:31], v[132:135], v[108:111]
ds_read_b128 v[132:135], v150 offset:6144
s_waitcnt lgkmcnt(5)
v_mfma_f32_16x16x32_bf16 v[76:79], v[24:27], v[136:139], v[76:79]
v_mfma_f32_16x16x32_bf16 v[112:115], v[28:31], v[136:139], v[112:115]
ds_read_b128 v[136:139], v150 offset:8192
s_waitcnt lgkmcnt(5)
v_mfma_f32_16x16x32_bf16 v[80:83], v[24:27], v[140:143], v[80:83]
v_mfma_f32_16x16x32_bf16 v[116:119], v[28:31], v[140:143], v[116:119]
L_q87:
s_waitcnt vmcnt(8)
s_barrier
s_add_u32 s93, s92, 11
s_sub_u32 s82, s93, 20
s_cmp_ge_u32 s93, 20
s_cselect_b32 s93, s82, s93
s_lshl_b32 s81, s93, 18
s_add_u32 s81, s81, s75
s_add_u32 m0, s76, 49152
s_add_u32 s82, s81, 0
buffer_load_dwordx4 v8, s[56:59], s82 offen lds
s_add_u32 m0, s76, 50176
s_add_u32 s82, s81, 16384
buffer_load_dwordx4 v9, s[56:59], s82 offen lds
s_add_u32 s93, s92, 10
s_sub_u32 s82, s93, 20
s_cmp_ge_u32 s93, 20
s_cselect_b32 s93, s82, s93
s_lshl_b32 s81, s93, 6
s_add_u32 m0, s77, 135168
s_add_u32 s82, s81, 0
buffer_load_dwordx4 v7, s[44:47], s82 offen lds
s_add_u32 m0, s77, 136192
s_add_u32 s82, s81, 10240
buffer_load_dwordx4 v7, s[44:47], s82 offen lds
s_cmp_ge_u32 s3, 8
s_cbranch_scc1 L_q88
ds_read_b64_tr_b16 v[24:25], v146 offset:16384
ds_read_b64_tr_b16 v[26:27], v146 offset:18432
ds_read_b64_tr_b16 v[28:29], v147 offset:16384
ds_read_b64_tr_b16 v[30:31], v147 offset:18432
ds_read_b128 v[140:143], v150 offset:10240
s_waitcnt lgkmcnt(9)
v_mfma_f32_16x16x32_bf16 v[48:51], v[16:19], v[120:123], v[48:51]
v_mfma_f32_16x16x32_bf16 v[84:87], v[20:23], v[120:123], v[84:87]
ds_read_b128 v[120:123], v150 offset:12288
s_waitcnt lgkmcnt(9)
v_mfma_f32_16x16x32_bf16 v[52:55], v[16:19], v[124:127], v[52:55]
v_mfma_f32_16x16x32_bf16 v[88:91], v[20:23], v[124:127], v[88:91]
ds_read_b128 v[124:127], v150 offset:14336
s_waitcnt lgkmcnt(9)
v_mfma_f32_16x16x32_bf16 v[56:59], v[16:19], v[128:131], v[56:59]
v_mfma_f32_16x16x32_bf16 v[92:95], v[20:23], v[128:131], v[92:95]
ds_read_b128 v[128:131], v150 offset:16384
s_waitcnt lgkmcnt(9)
v_mfma_f32_16x16x32_bf16 v[60:63], v[16:19], v[132:135], v[60:63]
v_mfma_f32_16x16x32_bf16 v[96:99], v[20:23], v[132:135], v[96:99]
ds_read_b128 v[132:135], v151
s_waitcnt lgkmcnt(9)
v_mfma_f32_16x16x32_bf16 v[64:67], v[16:19], v[136:139], v[64:67]
v_mfma_f32_16x16x32_bf16 v[100:103], v[20:23], v[136:139], v[100:103]
ds_read_b128 v[136:139], v151 offset:2048
s_waitcnt lgkmcnt(5)
v_mfma_f32_16x16x32_bf16 v[68:71], v[16:19], v[140:143], v[68:71]
v_mfma_f32_16x16x32_bf16 v[104:107], v[20:23], v[140:143], v[104:107]
ds_read_b128 v[140:143], v151 offset:4096
s_waitcnt lgkmcnt(5)
v_mfma_f32_16x16x32_bf16 v[72:75], v[16:19], v[120:123], v[72:75]
v_mfma_f32_16x16x32_bf16 v[108:111], v[20:23], v[120:123], v[108:111]
ds_read_b128 v[120:123], v151 offset:6144
s_waitcnt lgkmcnt(5)
v_mfma_f32_16x16x32_bf16 v[76:79], v[16:19], v[124:127], v[76:79]
v_mfma_f32_16x16x32_bf16 v[112:115], v[20:23], v[124:127], v[112:115]
ds_read_b128 v[124:127], v151 offset:8192
s_waitcnt lgkmcnt(5)
v_mfma_f32_16x16x32_bf16 v[80:83], v[16:19], v[128:131], v[80:83]
v_mfma_f32_16x16x32_bf16 v[116:119], v[20:23], v[128:131], v[116:119]
L_q88:
s_waitcnt vmcnt(6)
s_barrier
s_add_u32 s93, s92, 12
s_sub_u32 s82, s93, 20
s_cmp_ge_u32 s93, 20
s_cselect_b32 s93, s82, s93
s_lshl_b32 s81, s93, 18
s_add_u32 s81, s81, s75
s_add_u32 m0, s76, 65536
s_add_u32 s82, s81, 0
buffer_load_dwordx4 v8, s[56:59], s82 offen lds
s_add_u32 m0, s76, 66560
s_add_u32 s82, s81, 16384
buffer_load_dwordx4 v9, s[56:59], s82 offen lds
s_cmp_ge_u32 s3, 8
s_cbranch_scc1 L_q89
ds_read_b64_tr_b16 v[16:17], v144 offset:0
ds_read_b64_tr_b16 v[18:19], v144 offset:2048
ds_read_b64_tr_b16 v[20:21], v145 offset:0
ds_read_b64_tr_b16 v[22:23], v145 offset:2048
ds_read_b128 v[128:131], v151 offset:10240
s_waitcnt lgkmcnt(9)
v_mfma_f32_16x16x32_bf16 v[48:51], v[24:27], v[132:135], v[48:51]
v_mfma_f32_16x16x32_bf16 v[84:87], v[28:31], v[132:135], v[84:87]
ds_read_b128 v[132:135], v151 offset:12288
s_waitcnt lgkmcnt(9)
v_mfma_f32_16x16x32_bf16 v[52:55], v[24:27], v[136:139], v[52:55]
v_mfma_f32_16x16x32_bf16 v[88:91], v[28:31], v[136:139], v[88:91]
ds_read_b128 v[136:139], v151 offset:14336
s_waitcnt lgkmcnt(9)
v_mfma_f32_16x16x32_bf16 v[56:59], v[24:27], v[140:143], v[56:59]
v_mfma_f32_16x16x32_bf16 v[92:95], v[28:31], v[140:143], v[92:95]
ds_read_b128 v[140:143], v151 offset:16384
s_waitcnt lgkmcnt(9)
v_mfma_f32_16x16x32_bf16 v[60:63], v[24:27], v[120:123], v[60:63]
v_mfma_f32_16x16x32_bf16 v[96:99], v[28:31], v[120:123], v[96:99]
ds_read_b128 v[120:123], v150 offset:18432
s_waitcnt lgkmcnt(9)
v_mfma_f32_16x16x32_bf16 v[64:67], v[24:27], v[124:127], v[64:67]
v_mfma_f32_16x16x32_bf16 v[100:103], v[28:31], v[124:127], v[100:103]
ds_read_b128 v[124:127], v150 offset:20480
s_waitcnt lgkmcnt(5)
v_mfma_f32_16x16x32_bf16 v[68:71], v[24:27], v[128:131], v[68:71]
v_mfma_f32_16x16x32_bf16 v[104:107], v[28:31], v[128:131], v[104:107]
ds_read_b128 v[128:131], v150 offset:22528
s_waitcnt lgkmcnt(5)
v_mfma_f32_16x16x32_bf16 v[72:75], v[24:27], v[132:135], v[72:75]
v_mfma_f32_16x16x32_bf16 v[108:111], v[28:31], v[132:135], v[108:111]
ds_read_b128 v[132:135], v150 offset:24576
s_waitcnt lgkmcnt(5)
v_mfma_f32_16x16x32_bf16 v[76:79], v[24:27], v[136:139], v[76:79]
v_mfma_f32_16x16x32_bf16 v[112:115], v[28:31], v[136:139], v[112:115]
ds_read_b128 v[136:139], v150 offset:26624
s_waitcnt lgkmcnt(5)
v_mfma_f32_16x16x32_bf16 v[80:83], v[24:27], v[140:143], v[80:83]
v_mfma_f32_16x16x32_bf16 v[116:119], v[28:31], v[140:143], v[116:119]
L_q89:
s_waitcnt vmcnt(8)
s_barrier
s_add_u32 s93, s92, 13
s_sub_u32 s82, s93, 20
s_cmp_ge_u32 s93, 20
s_cselect_b32 s93, s82, s93
s_lshl_b32 s81, s93, 18
s_add_u32 s81, s81, s75
s_add_u32 m0, s76, 81920
s_add_u32 s82, s81, 0
buffer_load_dwordx4 v8, s[56:59], s82 offen lds
s_add_u32 m0, s76, 82944
s_add_u32 s82, s81, 16384
buffer_load_dwordx4 v9, s[56:59], s82 offen lds
s_add_u32 s93, s92, 12
s_sub_u32 s82, s93, 20
s_cmp_ge_u32 s93, 20
s_cselect_b32 s93, s82, s93
s_lshl_b32 s81, s93, 6
s_add_u32 m0, s77, 98304
s_add_u32 s82, s81, 0
buffer_load_dwordx4 v7, s[44:47], s82 offen lds
s_add_u32 m0, s77, 99328
s_add_u32 s82, s81, 10240
buffer_load_dwordx4 v7, s[44:47], s82 offen lds
s_cmp_ge_u32 s3, 8
s_cbranch_scc1 L_q810
ds_read_b64_tr_b16 v[24:25], v144 offset:16384
ds_read_b64_tr_b16 v[26:27], v144 offset:18432
ds_read_b64_tr_b16 v[28:29], v145 offset:16384
ds_read_b64_tr_b16 v[30:31], v145 offset:18432
ds_read_b128 v[140:143], v150 offset:28672
s_waitcnt lgkmcnt(9)
v_mfma_f32_16x16x32_bf16 v[48:51], v[16:19], v[120:123], v[48:51]
v_mfma_f32_16x16x32_bf16 v[84:87], v[20:23], v[120:123], v[84:87]
ds_read_b128 v[120:123], v150 offset:30720
s_waitcnt lgkmcnt(9)
v_mfma_f32_16x16x32_bf16 v[52:55], v[16:19], v[124:127], v[52:55]
v_mfma_f32_16x16x32_bf16 v[88:91], v[20:23], v[124:127], v[88:91]
ds_read_b128 v[124:127], v150 offset:32768
s_waitcnt lgkmcnt(9)
v_mfma_f32_16x16x32_bf16 v[56:59], v[16:19], v[128:131], v[56:59]
v_mfma_f32_16x16x32_bf16 v[92:95], v[20:23], v[128:131], v[92:95]
ds_read_b128 v[128:131], v150 offset:34816
s_waitcnt lgkmcnt(9)
v_mfma_f32_16x16x32_bf16 v[60:63], v[16:19], v[132:135], v[60:63]
v_mfma_f32_16x16x32_bf16 v[96:99], v[20:23], v[132:135], v[96:99]
ds_read_b128 v[132:135], v151 offset:18432
s_waitcnt lgkmcnt(9)
v_mfma_f32_16x16x32_bf16 v[64:67], v[16:19], v[136:139], v[64:67]
v_mfma_f32_16x16x32_bf16 v[100:103], v[20:23], v[136:139], v[100:103]
ds_read_b128 v[136:139], v151 offset:20480
s_waitcnt lgkmcnt(5)
v_mfma_f32_16x16x32_bf16 v[68:71], v[16:19], v[140:143], v[68:71]
v_mfma_f32_16x16x32_bf16 v[104:107], v[20:23], v[140:143], v[104:107]
ds_read_b128 v[140:143], v151 offset:22528
s_waitcnt lgkmcnt(5)
v_mfma_f32_16x16x32_bf16 v[72:75], v[16:19], v[120:123], v[72:75]
v_mfma_f32_16x16x32_bf16 v[108:111], v[20:23], v[120:123], v[108:111]
ds_read_b128 v[120:123], v151 offset:24576
s_waitcnt lgkmcnt(5)
v_mfma_f32_16x16x32_bf16 v[76:79], v[16:19], v[124:127], v[76:79]
v_mfma_f32_16x16x32_bf16 v[112:115], v[20:23], v[124:127], v[112:115]
ds_read_b128 v[124:127], v151 offset:26624
s_waitcnt lgkmcnt(5)
v_mfma_f32_16x16x32_bf16 v[80:83], v[16:19], v[128:131], v[80:83]
v_mfma_f32_16x16x32_bf16 v[116:119], v[20:23], v[128:131], v[116:119]
L_q810:
s_waitcnt vmcnt(6)
s_barrier
s_add_u32 s93, s92, 14
s_sub_u32 s82, s93, 20
s_cmp_ge_u32 s93, 20
s_cselect_b32 s93, s82, s93
s_lshl_b32 s81, s93, 18
s_add_u32 s81, s81, s75
s_add_u32 m0, s76, 0
s_add_u32 s82, s81, 0
buffer_load_dwordx4 v8, s[56:59], s82 offen lds
s_add_u32 m0, s76, 1024
s_add_u32 s82, s81, 16384
buffer_load_dwordx4 v9, s[56:59], s82 offen lds
s_cmp_ge_u32 s3, 8
s_cbranch_scc1 L_q811
ds_read_b64_tr_b16 v[16:17], v144 offset:32768
ds_read_b64_tr_b16 v[18:19], v144 offset:34816
ds_read_b64_tr_b16 v[20:21], v145 offset:32768
ds_read_b64_tr_b16 v[22:23], v145 offset:34816
ds_read_b128 v[128:131], v151 offset:28672
s_waitcnt lgkmcnt(9)
v_mfma_f32_16x16x32_bf16 v[48:51], v[24:27], v[132:135], v[48:51]
v_mfma_f32_16x16x32_bf16 v[84:87], v[28:31], v[132:135], v[84:87]
ds_read_b128 v[132:135], v151 offset:30720
s_waitcnt lgkmcnt(9)
v_mfma_f32_16x16x32_bf16 v[52:55], v[24:27], v[136:139], v[52:55]
v_mfma_f32_16x16x32_bf16 v[88:91], v[28:31], v[136:139], v[88:91]
ds_read_b128 v[136:139], v151 offset:32768
s_waitcnt lgkmcnt(9)
v_mfma_f32_16x16x32_bf16 v[56:59], v[24:27], v[140:143], v[56:59]
v_mfma_f32_16x16x32_bf16 v[92:95], v[28:31], v[140:143], v[92:95]
ds_read_b128 v[140:143], v151 offset:34816
s_waitcnt lgkmcnt(9)
v_mfma_f32_16x16x32_bf16 v[60:63], v[24:27], v[120:123], v[60:63]
v_mfma_f32_16x16x32_bf16 v[96:99], v[28:31], v[120:123], v[96:99]
ds_read_b128 v[120:123], v150 offset:36864
s_waitcnt lgkmcnt(9)
v_mfma_f32_16x16x32_bf16 v[64:67], v[24:27], v[124:127], v[64:67]
v_mfma_f32_16x16x32_bf16 v[100:103], v[28:31], v[124:127], v[100:103]
ds_read_b128 v[124:127], v150 offset:38912
s_waitcnt lgkmcnt(5)
v_mfma_f32_16x16x32_bf16 v[68:71], v[24:27], v[128:131], v[68:71]
v_mfma_f32_16x16x32_bf16 v[104:107], v[28:31], v[128:131], v[104:107]
ds_read_b128 v[128:131], v150 offset:40960
s_waitcnt lgkmcnt(5)
v_mfma_f32_16x16x32_bf16 v[72:75], v[24:27], v[132:135], v[72:75]
v_mfma_f32_16x16x32_bf16 v[108:111], v[28:31], v[132:135], v[108:111]
ds_read_b128 v[132:135], v150 offset:43008
s_waitcnt lgkmcnt(5)
v_mfma_f32_16x16x32_bf16 v[76:79], v[24:27], v[136:139], v[76:79]
v_mfma_f32_16x16x32_bf16 v[112:115], v[28:31], v[136:139], v[112:115]
ds_read_b128 v[136:139], v150 offset:45056
s_waitcnt lgkmcnt(5)
v_mfma_f32_16x16x32_bf16 v[80:83], v[24:27], v[140:143], v[80:83]
v_mfma_f32_16x16x32_bf16 v[116:119], v[28:31], v[140:143], v[116:119]
L_q811:
s_waitcnt vmcnt(8)
s_barrier
s_add_u32 s93, s92, 15
s_sub_u32 s82, s93, 20
s_cmp_ge_u32 s93, 20
s_cselect_b32 s93, s82, s93
s_lshl_b32 s81, s93, 18
s_add_u32 s81, s81, s75
s_add_u32 m0, s76, 16384
s_add_u32 s82, s81, 0
buffer_load_dwordx4 v8, s[56:59], s82 offen lds
s_add_u32 m0, s76, 17408
s_add_u32 s82, s81, 16384
buffer_load_dwordx4 v9, s[56:59], s82 offen lds
s_add_u32 s93, s92, 14
s_sub_u32 s82, s93, 20
s_cmp_ge_u32 s93, 20
s_cselect_b32 s93, s82, s93
s_lshl_b32 s81, s93, 6
s_add_u32 m0, s77, 116736
s_add_u32 s82, s81, 0
buffer_load_dwordx4 v7, s[44:47], s82 offen lds
s_add_u32 m0, s77, 117760
s_add_u32 s82, s81, 10240
buffer_load_dwordx4 v7, s[44:47], s82 offen lds
s_cmp_ge_u32 s3, 8
s_cbranch_scc1 L_q812
ds_read_b64_tr_b16 v[24:25], v144 offset:49152
ds_read_b64_tr_b16 v[26:27], v144 offset:51200
ds_read_b64_tr_b16 v[28:29], v145 offset:49152
ds_read_b64_tr_b16 v[30:31], v145 offset:51200
ds_read_b128 v[140:143], v150 offset:47104
s_waitcnt lgkmcnt(9)
v_mfma_f32_16x16x32_bf16 v[48:51], v[16:19], v[120:123], v[48:51]
v_mfma_f32_16x16x32_bf16 v[84:87], v[20:23], v[120:123], v[84:87]
ds_read_b128 v[120:123], v150 offset:49152
s_waitcnt lgkmcnt(9)
v_mfma_f32_16x16x32_bf16 v[52:55], v[16:19], v[124:127], v[52:55]
v_mfma_f32_16x16x32_bf16 v[88:91], v[20:23], v[124:127], v[88:91]
ds_read_b128 v[124:127], v150 offset:51200
s_waitcnt lgkmcnt(9)
v_mfma_f32_16x16x32_bf16 v[56:59], v[16:19], v[128:131], v[56:59]
v_mfma_f32_16x16x32_bf16 v[92:95], v[20:23], v[128:131], v[92:95]
ds_read_b128 v[128:131], v150 offset:53248
s_waitcnt lgkmcnt(9)
v_mfma_f32_16x16x32_bf16 v[60:63], v[16:19], v[132:135], v[60:63]
v_mfma_f32_16x16x32_bf16 v[96:99], v[20:23], v[132:135], v[96:99]
ds_read_b128 v[132:135], v151 offset:36864
s_waitcnt lgkmcnt(9)
v_mfma_f32_16x16x32_bf16 v[64:67], v[16:19], v[136:139], v[64:67]
v_mfma_f32_16x16x32_bf16 v[100:103], v[20:23], v[136:139], v[100:103]
ds_read_b128 v[136:139], v151 offset:38912
s_waitcnt lgkmcnt(5)
v_mfma_f32_16x16x32_bf16 v[68:71], v[16:19], v[140:143], v[68:71]
v_mfma_f32_16x16x32_bf16 v[104:107], v[20:23], v[140:143], v[104:107]
ds_read_b128 v[140:143], v151 offset:40960
s_waitcnt lgkmcnt(5)
v_mfma_f32_16x16x32_bf16 v[72:75], v[16:19], v[120:123], v[72:75]
v_mfma_f32_16x16x32_bf16 v[108:111], v[20:23], v[120:123], v[108:111]
ds_read_b128 v[120:123], v151 offset:43008
s_waitcnt lgkmcnt(5)
v_mfma_f32_16x16x32_bf16 v[76:79], v[16:19], v[124:127], v[76:79]
v_mfma_f32_16x16x32_bf16 v[112:115], v[20:23], v[124:127], v[112:115]
ds_read_b128 v[124:127], v151 offset:45056
s_waitcnt lgkmcnt(5)
v_mfma_f32_16x16x32_bf16 v[80:83], v[16:19], v[128:131], v[80:83]
v_mfma_f32_16x16x32_bf16 v[116:119], v[20:23], v[128:131], v[116:119]
L_q812:
s_waitcnt vmcnt(6)
s_barrier
s_add_u32 s93, s92, 16
s_sub_u32 s82, s93, 20
s_cmp_ge_u32 s93, 20
s_cselect_b32 s93, s82, s93
s_lshl_b32 s81, s93, 18
s_add_u32 s81, s81, s75
s_add_u32 m0, s76, 32768
s_add_u32 s82, s81, 0
buffer_load_dwordx4 v8, s[56:59], s82 offen lds
s_add_u32 m0, s76, 33792
s_add_u32 s82, s81, 16384
buffer_load_dwordx4 v9, s[56:59], s82 offen lds
s_cmp_ge_u32 s3, 8
s_cbranch_scc1 L_q813
ds_read_b64_tr_b16 v[16:17], v146 offset:0
ds_read_b64_tr_b16 v[18:19], v146 offset:2048
ds_read_b64_tr_b16 v[20:21], v147 offset:0
ds_read_b64_tr_b16 v[22:23], v147 offset:2048
ds_read_b128 v[128:131], v151 offset:47104
s_waitcnt lgkmcnt(9)
v_mfma_f32_16x16x32_bf16 v[48:51], v[24:27], v[132:135], v[48:51]
v_mfma_f32_16x16x32_bf16 v[84:87], v[28:31], v[132:135], v[84:87]
ds_read_b128 v[132:135], v151 offset:49152
s_waitcnt lgkmcnt(9)
v_mfma_f32_16x16x32_bf16 v[52:55], v[24:27], v[136:139], v[52:55]
v_mfma_f32_16x16x32_bf16 v[88:91], v[28:31], v[136:139], v[88:91]
ds_read_b128 v[136:139], v151 offset:51200
s_waitcnt lgkmcnt(9)
v_mfma_f32_16x16x32_bf16 v[56:59], v[24:27], v[140:143], v[56:59]
v_mfma_f32_16x16x32_bf16 v[92:95], v[28:31], v[140:143], v[92:95]
ds_read_b128 v[140:143], v151 offset:53248
s_waitcnt lgkmcnt(9)
v_mfma_f32_16x16x32_bf16 v[60:63], v[24:27], v[120:123], v[60:63]
v_mfma_f32_16x16x32_bf16 v[96:99], v[28:31], v[120:123], v[96:99]
ds_read_b128 v[120:123], v150
s_waitcnt lgkmcnt(9)
v_mfma_f32_16x16x32_bf16 v[64:67], v[24:27], v[124:127], v[64:67]
v_mfma_f32_16x16x32_bf16 v[100:103], v[28:31], v[124:127], v[100:103]
ds_read_b128 v[124:127], v150 offset:2048
s_waitcnt lgkmcnt(5)
v_mfma_f32_16x16x32_bf16 v[68:71], v[24:27], v[128:131], v[68:71]
v_mfma_f32_16x16x32_bf16 v[104:107], v[28:31], v[128:131], v[104:107]
ds_read_b128 v[128:131], v150 offset:4096
s_waitcnt lgkmcnt(5)
v_mfma_f32_16x16x32_bf16 v[72:75], v[24:27], v[132:135], v[72:75]
v_mfma_f32_16x16x32_bf16 v[108:111], v[28:31], v[132:135], v[108:111]
ds_read_b128 v[132:135], v150 offset:6144
s_waitcnt lgkmcnt(5)
v_mfma_f32_16x16x32_bf16 v[76:79], v[24:27], v[136:139], v[76:79]
v_mfma_f32_16x16x32_bf16 v[112:115], v[28:31], v[136:139], v[112:115]
ds_read_b128 v[136:139], v150 offset:8192
s_waitcnt lgkmcnt(5)
v_mfma_f32_16x16x32_bf16 v[80:83], v[24:27], v[140:143], v[80:83]
v_mfma_f32_16x16x32_bf16 v[116:119], v[28:31], v[140:143], v[116:119]
L_q813:
s_waitcnt vmcnt(8)
s_barrier
s_add_u32 s93, s92, 17
s_sub_u32 s82, s93, 20
s_cmp_ge_u32 s93, 20
s_cselect_b32 s93, s82, s93
s_lshl_b32 s81, s93, 18
s_add_u32 s81, s81, s75
s_add_u32 m0, s76, 49152
s_add_u32 s82, s81, 0
buffer_load_dwordx4 v8, s[56:59], s82 offen lds
s_add_u32 m0, s76, 50176
s_add_u32 s82, s81, 16384
buffer_load_dwordx4 v9, s[56:59], s82 offen lds
s_add_u32 s93, s92, 16
s_sub_u32 s82, s93, 20
s_cmp_ge_u32 s93, 20
s_cselect_b32 s93, s82, s93
s_lshl_b32 s81, s93, 6
s_add_u32 m0, s77, 135168
s_add_u32 s82, s81, 0
buffer_load_dwordx4 v7, s[44:47], s82 offen lds
s_add_u32 m0, s77, 136192
s_add_u32 s82, s81, 10240
buffer_load_dwordx4 v7, s[44:47], s82 offen lds
s_cmp_ge_u32 s3, 8
s_cbranch_scc1 L_q814
ds_read_b64_tr_b16 v[24:25], v146 offset:16384
ds_read_b64_tr_b16 v[26:27], v146 offset:18432
ds_read_b64_tr_b16 v[28:29], v147 offset:16384
ds_read_b64_tr_b16 v[30:31], v147 offset:18432
ds_read_b128 v[140:143], v150 offset:10240
s_waitcnt lgkmcnt(9)
v_mfma_f32_16x16x32_bf16 v[48:51], v[16:19], v[120:123], v[48:51]
v_mfma_f32_16x16x32_bf16 v[84:87], v[20:23], v[120:123], v[84:87]
ds_read_b128 v[120:123], v150 offset:12288
s_waitcnt lgkmcnt(9)
v_mfma_f32_16x16x32_bf16 v[52:55], v[16:19], v[124:127], v[52:55]
v_mfma_f32_16x16x32_bf16 v[88:91], v[20:23], v[124:127], v[88:91]
ds_read_b128 v[124:127], v150 offset:14336
s_waitcnt lgkmcnt(9)
v_mfma_f32_16x16x32_bf16 v[56:59], v[16:19], v[128:131], v[56:59]
v_mfma_f32_16x16x32_bf16 v[92:95], v[20:23], v[128:131], v[92:95]
ds_read_b128 v[128:131], v150 offset:16384
s_waitcnt lgkmcnt(9)
v_mfma_f32_16x16x32_bf16 v[60:63], v[16:19], v[132:135], v[60:63]
v_mfma_f32_16x16x32_bf16 v[96:99], v[20:23], v[132:135], v[96:99]
ds_read_b128 v[132:135], v151
s_waitcnt lgkmcnt(9)
v_mfma_f32_16x16x32_bf16 v[64:67], v[16:19], v[136:139], v[64:67]
v_mfma_f32_16x16x32_bf16 v[100:103], v[20:23], v[136:139], v[100:103]
ds_read_b128 v[136:139], v151 offset:2048
s_waitcnt lgkmcnt(5)
v_mfma_f32_16x16x32_bf16 v[68:71], v[16:19], v[140:143], v[68:71]
v_mfma_f32_16x16x32_bf16 v[104:107], v[20:23], v[140:143], v[104:107]
ds_read_b128 v[140:143], v151 offset:4096
s_waitcnt lgkmcnt(5)
v_mfma_f32_16x16x32_bf16 v[72:75], v[16:19], v[120:123], v[72:75]
v_mfma_f32_16x16x32_bf16 v[108:111], v[20:23], v[120:123], v[108:111]
ds_read_b128 v[120:123], v151 offset:6144
s_waitcnt lgkmcnt(5)
v_mfma_f32_16x16x32_bf16 v[76:79], v[16:19], v[124:127], v[76:79]
v_mfma_f32_16x16x32_bf16 v[112:115], v[20:23], v[124:127], v[112:115]
ds_read_b128 v[124:127], v151 offset:8192
s_waitcnt lgkmcnt(5)
v_mfma_f32_16x16x32_bf16 v[80:83], v[16:19], v[128:131], v[80:83]
v_mfma_f32_16x16x32_bf16 v[116:119], v[20:23], v[128:131], v[116:119]
L_q814:
s_waitcnt vmcnt(6)
s_barrier
s_add_u32 s93, s92, 18
s_sub_u32 s82, s93, 20
s_cmp_ge_u32 s93, 20
s_cselect_b32 s93, s82, s93
s_lshl_b32 s81, s93, 18
s_add_u32 s81, s81, s75
s_add_u32 m0, s76, 65536
s_add_u32 s82, s81, 0
buffer_load_dwordx4 v8, s[56:59], s82 offen lds
s_add_u32 m0, s76, 66560
s_add_u32 s82, s81, 16384
buffer_load_dwordx4 v9, s[56:59], s82 offen lds
s_cmp_ge_u32 s3, 8
s_cbranch_scc1 L_q815
ds_read_b64_tr_b16 v[16:17], v144 offset:0
ds_read_b64_tr_b16 v[18:19], v144 offset:2048
ds_read_b64_tr_b16 v[20:21], v145 offset:0
ds_read_b64_tr_b16 v[22:23], v145 offset:2048
ds_read_b128 v[128:131], v151 offset:10240
s_waitcnt lgkmcnt(9)
v_mfma_f32_16x16x32_bf16 v[48:51], v[24:27], v[132:135], v[48:51]
v_mfma_f32_16x16x32_bf16 v[84:87], v[28:31], v[132:135], v[84:87]
ds_read_b128 v[132:135], v151 offset:12288
s_waitcnt lgkmcnt(9)
v_mfma_f32_16x16x32_bf16 v[52:55], v[24:27], v[136:139], v[52:55]
v_mfma_f32_16x16x32_bf16 v[88:91], v[28:31], v[136:139], v[88:91]
ds_read_b128 v[136:139], v151 offset:14336
s_waitcnt lgkmcnt(9)
v_mfma_f32_16x16x32_bf16 v[56:59], v[24:27], v[140:143], v[56:59]
v_mfma_f32_16x16x32_bf16 v[92:95], v[28:31], v[140:143], v[92:95]
ds_read_b128 v[140:143], v151 offset:16384
s_waitcnt lgkmcnt(9)
v_mfma_f32_16x16x32_bf16 v[60:63], v[24:27], v[120:123], v[60:63]
v_mfma_f32_16x16x32_bf16 v[96:99], v[28:31], v[120:123], v[96:99]
ds_read_b128 v[120:123], v150 offset:18432
s_waitcnt lgkmcnt(9)
v_mfma_f32_16x16x32_bf16 v[64:67], v[24:27], v[124:127], v[64:67]
v_mfma_f32_16x16x32_bf16 v[100:103], v[28:31], v[124:127], v[100:103]
ds_read_b128 v[124:127], v150 offset:20480
s_waitcnt lgkmcnt(5)
v_mfma_f32_16x16x32_bf16 v[68:71], v[24:27], v[128:131], v[68:71]
v_mfma_f32_16x16x32_bf16 v[104:107], v[28:31], v[128:131], v[104:107]
ds_read_b128 v[128:131], v150 offset:22528
s_waitcnt lgkmcnt(5)
v_mfma_f32_16x16x32_bf16 v[72:75], v[24:27], v[132:135], v[72:75]
v_mfma_f32_16x16x32_bf16 v[108:111], v[28:31], v[132:135], v[108:111]
ds_read_b128 v[132:135], v150 offset:24576
s_waitcnt lgkmcnt(5)
v_mfma_f32_16x16x32_bf16 v[76:79], v[24:27], v[136:139], v[76:79]
v_mfma_f32_16x16x32_bf16 v[112:115], v[28:31], v[136:139], v[112:115]
ds_read_b128 v[136:139], v150 offset:26624
s_waitcnt lgkmcnt(5)
v_mfma_f32_16x16x32_bf16 v[80:83], v[24:27], v[140:143], v[80:83]
v_mfma_f32_16x16x32_bf16 v[116:119], v[28:31], v[140:143], v[116:119]
L_q815:
s_waitcnt vmcnt(8)
s_barrier
s_add_u32 s93, s92, 19
s_sub_u32 s82, s93, 20
s_cmp_ge_u32 s93, 20
s_cselect_b32 s93, s82, s93
s_lshl_b32 s81, s93, 18
s_add_u32 s81, s81, s75
s_add_u32 m0, s76, 81920
s_add_u32 s82, s81, 0
buffer_load_dwordx4 v8, s[56:59], s82 offen lds
s_add_u32 m0, s76, 82944
s_add_u32 s82, s81, 16384
buffer_load_dwordx4 v9, s[56:59], s82 offen lds
s_add_u32 s93, s92, 18
s_sub_u32 s82, s93, 20
s_cmp_ge_u32 s93, 20
s_cselect_b32 s93, s82, s93
s_lshl_b32 s81, s93, 6
s_add_u32 m0, s77, 98304
s_add_u32 s82, s81, 0
buffer_load_dwordx4 v7, s[44:47], s82 offen lds
s_add_u32 m0, s77, 99328
s_add_u32 s82, s81, 10240
buffer_load_dwordx4 v7, s[44:47], s82 offen lds
s_cmp_ge_u32 s3, 8
s_cbranch_scc1 L_q816
ds_read_b64_tr_b16 v[24:25], v144 offset:16384
ds_read_b64_tr_b16 v[26:27], v144 offset:18432
ds_read_b64_tr_b16 v[28:29], v145 offset:16384
ds_read_b64_tr_b16 v[30:31], v145 offset:18432
ds_read_b128 v[140:143], v150 offset:28672
s_waitcnt lgkmcnt(9)
v_mfma_f32_16x16x32_bf16 v[48:51], v[16:19], v[120:123], v[48:51]
v_mfma_f32_16x16x32_bf16 v[84:87], v[20:23], v[120:123], v[84:87]
ds_read_b128 v[120:123], v150 offset:30720
s_waitcnt lgkmcnt(9)
v_mfma_f32_16x16x32_bf16 v[52:55], v[16:19], v[124:127], v[52:55]
v_mfma_f32_16x16x32_bf16 v[88:91], v[20:23], v[124:127], v[88:91]
ds_read_b128 v[124:127], v150 offset:32768
s_waitcnt lgkmcnt(9)
v_mfma_f32_16x16x32_bf16 v[56:59], v[16:19], v[128:131], v[56:59]
v_mfma_f32_16x16x32_bf16 v[92:95], v[20:23], v[128:131], v[92:95]
ds_read_b128 v[128:131], v150 offset:34816
s_waitcnt lgkmcnt(9)
v_mfma_f32_16x16x32_bf16 v[60:63], v[16:19], v[132:135], v[60:63]
v_mfma_f32_16x16x32_bf16 v[96:99], v[20:23], v[132:135], v[96:99]
ds_read_b128 v[132:135], v151 offset:18432
s_waitcnt lgkmcnt(9)
v_mfma_f32_16x16x32_bf16 v[64:67], v[16:19], v[136:139], v[64:67]
v_mfma_f32_16x16x32_bf16 v[100:103], v[20:23], v[136:139], v[100:103]
ds_read_b128 v[136:139], v151 offset:20480
s_waitcnt lgkmcnt(5)
v_mfma_f32_16x16x32_bf16 v[68:71], v[16:19], v[140:143], v[68:71]
v_mfma_f32_16x16x32_bf16 v[104:107], v[20:23], v[140:143], v[104:107]
ds_read_b128 v[140:143], v151 offset:22528
s_waitcnt lgkmcnt(5)
v_mfma_f32_16x16x32_bf16 v[72:75], v[16:19], v[120:123], v[72:75]
v_mfma_f32_16x16x32_bf16 v[108:111], v[20:23], v[120:123], v[108:111]
ds_read_b128 v[120:123], v151 offset:24576
s_waitcnt lgkmcnt(5)
v_mfma_f32_16x16x32_bf16 v[76:79], v[16:19], v[124:127], v[76:79]
v_mfma_f32_16x16x32_bf16 v[112:115], v[20:23], v[124:127], v[112:115]
ds_read_b128 v[124:127], v151 offset:26624
s_waitcnt lgkmcnt(5)
v_mfma_f32_16x16x32_bf16 v[80:83], v[16:19], v[128:131], v[80:83]
v_mfma_f32_16x16x32_bf16 v[116:119], v[20:23], v[128:131], v[116:119]
L_q816:
s_waitcnt vmcnt(6)
s_barrier
s_cmp_ge_u32 s3, 8
s_cbranch_scc1 L_q817
ds_read_b64_tr_b16 v[16:17], v144 offset:32768
ds_read_b64_tr_b16 v[18:19], v144 offset:34816
ds_read_b64_tr_b16 v[20:21], v145 offset:32768
ds_read_b64_tr_b16 v[22:23], v145 offset:34816
ds_read_b128 v[128:131], v151 offset:28672
s_waitcnt lgkmcnt(9)
v_mfma_f32_16x16x32_bf16 v[48:51], v[24:27], v[132:135], v[48:51]
v_mfma_f32_16x16x32_bf16 v[84:87], v[28:31], v[132:135], v[84:87]
ds_read_b128 v[132:135], v151 offset:30720
s_waitcnt lgkmcnt(9)
v_mfma_f32_16x16x32_bf16 v[52:55], v[24:27], v[136:139], v[52:55]
v_mfma_f32_16x16x32_bf16 v[88:91], v[28:31], v[136:139], v[88:91]
ds_read_b128 v[136:139], v151 offset:32768
s_waitcnt lgkmcnt(9)
v_mfma_f32_16x16x32_bf16 v[56:59], v[24:27], v[140:143], v[56:59]
v_mfma_f32_16x16x32_bf16 v[92:95], v[28:31], v[140:143], v[92:95]
ds_read_b128 v[140:143], v151 offset:34816
s_waitcnt lgkmcnt(9)
v_mfma_f32_16x16x32_bf16 v[60:63], v[24:27], v[120:123], v[60:63]
v_mfma_f32_16x16x32_bf16 v[96:99], v[28:31], v[120:123], v[96:99]
ds_read_b128 v[120:123], v150 offset:36864
s_waitcnt lgkmcnt(9)
v_mfma_f32_16x16x32_bf16 v[64:67], v[24:27], v[124:127], v[64:67]
v_mfma_f32_16x16x32_bf16 v[100:103], v[28:31], v[124:127], v[100:103]
ds_read_b128 v[124:127], v150 offset:38912
s_waitcnt lgkmcnt(5)
v_mfma_f32_16x16x32_bf16 v[68:71], v[24:27], v[128:131], v[68:71]
v_mfma_f32_16x16x32_bf16 v[104:107], v[28:31], v[128:131], v[104:107]
ds_read_b128 v[128:131], v150 offset:40960
s_waitcnt lgkmcnt(5)
v_mfma_f32_16x16x32_bf16 v[72:75], v[24:27], v[132:135], v[72:75]
v_mfma_f32_16x16x32_bf16 v[108:111], v[28:31], v[132:135], v[108:111]
ds_read_b128 v[132:135], v150 offset:43008
s_waitcnt lgkmcnt(5)
v_mfma_f32_16x16x32_bf16 v[76:79], v[24:27], v[136:139], v[76:79]
v_mfma_f32_16x16x32_bf16 v[112:115], v[28:31], v[136:139], v[112:115]
ds_read_b128 v[136:139], v150 offset:45056
s_waitcnt lgkmcnt(5)
v_mfma_f32_16x16x32_bf16 v[80:83], v[24:27], v[140:143], v[80:83]
v_mfma_f32_16x16x32_bf16 v[116:119], v[28:31], v[140:143], v[116:119]
L_q817:
s_waitcnt vmcnt(6)
s_barrier
s_mov_b32 s95, 0
s_mov_b32 s96, 0
s_add_u32 s83, s96, s76
s_add_u32 s81, s95, s76
s_add_u32 m0, s83, 0
s_add_u32 s82, s81, 0
buffer_load_dwordx4 v10, s[48:51], s82 offen nt lds
s_add_u32 m0, s83, 1024
s_add_u32 s82, s81, 1024
buffer_load_dwordx4 v11, s[48:51], s82 offen nt lds
s_add_u32 m0, s83, 16384
s_add_u32 s82, s81, 0
buffer_load_dwordx4 v12, s[52:55], s82 offen nt lds
s_add_u32 m0, s83, 17408
s_add_u32 s82, s81, 1024
buffer_load_dwordx4 v13, s[52:55], s82 offen nt lds
s_cmp_ge_u32 s3, 8
s_cbranch_scc1 L_q818
ds_read_b64_tr_b16 v[24:25], v144 offset:49152
ds_read_b64_tr_b16 v[26:27], v144 offset:51200
ds_read_b64_tr_b16 v[28:29], v145 offset:49152
ds_read_b64_tr_b16 v[30:31], v145 offset:51200
ds_read_b128 v[140:143], v150 offset:47104
s_waitcnt lgkmcnt(9)
v_mfma_f32_16x16x32_bf16 v[48:51], v[16:19], v[120:123], v[48:51]
v_mfma_f32_16x16x32_bf16 v[84:87], v[20:23], v[120:123], v[84:87]
ds_read_b128 v[120:123], v150 offset:49152
s_waitcnt lgkmcnt(9)
v_mfma_f32_16x16x32_bf16 v[52:55], v[16:19], v[124:127], v[52:55]
v_mfma_f32_16x16x32_bf16 v[88:91], v[20:23], v[124:127], v[88:91]
ds_read_b128 v[124:127], v150 offset:51200
s_waitcnt lgkmcnt(9)
v_mfma_f32_16x16x32_bf16 v[56:59], v[16:19], v[128:131], v[56:59]
v_mfma_f32_16x16x32_bf16 v[92:95], v[20:23], v[128:131], v[92:95]
ds_read_b128 v[128:131], v150 offset:53248
s_waitcnt lgkmcnt(9)
v_mfma_f32_16x16x32_bf16 v[60:63], v[16:19], v[132:135], v[60:63]
v_mfma_f32_16x16x32_bf16 v[96:99], v[20:23], v[132:135], v[96:99]
ds_read_b128 v[132:135], v151 offset:36864
s_waitcnt lgkmcnt(9)
v_mfma_f32_16x16x32_bf16 v[64:67], v[16:19], v[136:139], v[64:67]
v_mfma_f32_16x16x32_bf16 v[100:103], v[20:23], v[136:139], v[100:103]
ds_read_b128 v[136:139], v151 offset:38912
s_waitcnt lgkmcnt(5)
v_mfma_f32_16x16x32_bf16 v[68:71], v[16:19], v[140:143], v[68:71]
v_mfma_f32_16x16x32_bf16 v[104:107], v[20:23], v[140:143], v[104:107]
ds_read_b128 v[140:143], v151 offset:40960
s_waitcnt lgkmcnt(5)
v_mfma_f32_16x16x32_bf16 v[72:75], v[16:19], v[120:123], v[72:75]
v_mfma_f32_16x16x32_bf16 v[108:111], v[20:23], v[120:123], v[108:111]
ds_read_b128 v[120:123], v151 offset:43008
s_waitcnt lgkmcnt(5)
v_mfma_f32_16x16x32_bf16 v[76:79], v[16:19], v[124:127], v[76:79]
v_mfma_f32_16x16x32_bf16 v[112:115], v[20:23], v[124:127], v[112:115]
ds_read_b128 v[124:127], v151 offset:45056
s_waitcnt lgkmcnt(5)
v_mfma_f32_16x16x32_bf16 v[80:83], v[16:19], v[128:131], v[80:83]
v_mfma_f32_16x16x32_bf16 v[116:119], v[20:23], v[128:131], v[116:119]
L_q818:
s_waitcnt vmcnt(4)
s_barrier
s_cmp_ge_u32 s3, 8
s_cbranch_scc1 L_q819
ds_read_b64_tr_b16 v[16:17], v146 offset:0
ds_read_b64_tr_b16 v[18:19], v146 offset:2048
ds_read_b64_tr_b16 v[20:21], v147 offset:0
ds_read_b64_tr_b16 v[22:23], v147 offset:2048
ds_read_b128 v[128:131], v151 offset:47104
s_waitcnt lgkmcnt(9)
v_mfma_f32_16x16x32_bf16 v[48:51], v[24:27], v[132:135], v[48:51]
v_mfma_f32_16x16x32_bf16 v[84:87], v[28:31], v[132:135], v[84:87]
ds_read_b128 v[132:135], v151 offset:49152
s_waitcnt lgkmcnt(9)
v_mfma_f32_16x16x32_bf16 v[52:55], v[24:27], v[136:139], v[52:55]
v_mfma_f32_16x16x32_bf16 v[88:91], v[28:31], v[136:139], v[88:91]
ds_read_b128 v[136:139], v151 offset:51200
s_waitcnt lgkmcnt(9)
v_mfma_f32_16x16x32_bf16 v[56:59], v[24:27], v[140:143], v[56:59]
v_mfma_f32_16x16x32_bf16 v[92:95], v[28:31], v[140:143], v[92:95]
ds_read_b128 v[140:143], v151 offset:53248
s_waitcnt lgkmcnt(9)
v_mfma_f32_16x16x32_bf16 v[60:63], v[24:27], v[120:123], v[60:63]
v_mfma_f32_16x16x32_bf16 v[96:99], v[28:31], v[120:123], v[96:99]
ds_read_b128 v[120:123], v150
s_waitcnt lgkmcnt(9)
v_mfma_f32_16x16x32_bf16 v[64:67], v[24:27], v[124:127], v[64:67]
v_mfma_f32_16x16x32_bf16 v[100:103], v[28:31], v[124:127], v[100:103]
ds_read_b128 v[124:127], v150 offset:2048
s_waitcnt lgkmcnt(5)
v_mfma_f32_16x16x32_bf16 v[68:71], v[24:27], v[128:131], v[68:71]
v_mfma_f32_16x16x32_bf16 v[104:107], v[28:31], v[128:131], v[104:107]
ds_read_b128 v[128:131], v150 offset:4096
s_waitcnt lgkmcnt(5)
v_mfma_f32_16x16x32_bf16 v[72:75], v[24:27], v[132:135], v[72:75]
v_mfma_f32_16x16x32_bf16 v[108:111], v[28:31], v[132:135], v[108:111]
ds_read_b128 v[132:135], v150 offset:6144
s_waitcnt lgkmcnt(5)
v_mfma_f32_16x16x32_bf16 v[76:79], v[24:27], v[136:139], v[76:79]
v_mfma_f32_16x16x32_bf16 v[112:115], v[28:31], v[136:139], v[112:115]
ds_read_b128 v[136:139], v150 offset:8192
s_waitcnt lgkmcnt(5)
v_mfma_f32_16x16x32_bf16 v[80:83], v[24:27], v[140:143], v[80:83]
v_mfma_f32_16x16x32_bf16 v[116:119], v[28:31], v[140:143], v[116:119]
L_q819:
s_waitcnt vmcnt(4)
s_barrier
s_mov_b32 s95, 16384
s_mov_b32 s96, 32768
s_add_u32 s83, s96, s76
s_add_u32 s81, s95, s76
s_add_u32 m0, s83, 0
s_add_u32 s82, s81, 0
buffer_load_dwordx4 v10, s[48:51], s82 offen nt lds
s_add_u32 m0, s83, 1024
s_add_u32 s82, s81, 1024
buffer_load_dwordx4 v11, s[48:51], s82 offen nt lds
s_add_u32 m0, s83, 16384
s_add_u32 s82, s81, 0
buffer_load_dwordx4 v12, s[52:55], s82 offen nt lds
s_add_u32 m0, s83, 17408
s_add_u32 s82, s81, 1024
buffer_load_dwordx4 v13, s[52:55], s82 offen nt lds
s_cmp_ge_u32 s3, 8
s_cbranch_scc1 L_q820
ds_read_b64_tr_b16 v[24:25], v146 offset:16384
ds_read_b64_tr_b16 v[26:27], v146 offset:18432
ds_read_b64_tr_b16 v[28:29], v147 offset:16384
ds_read_b64_tr_b16 v[30:31], v147 offset:18432
ds_read_b128 v[140:143], v150 offset:10240
s_waitcnt lgkmcnt(9)
v_mfma_f32_16x16x32_bf16 v[48:51], v[16:19], v[120:123], v[48:51]
v_mfma_f32_16x16x32_bf16 v[84:87], v[20:23], v[120:123], v[84:87]
ds_read_b128 v[120:123], v150 offset:12288
s_waitcnt lgkmcnt(9)
v_mfma_f32_16x16x32_bf16 v[52:55], v[16:19], v[124:127], v[52:55]
v_mfma_f32_16x16x32_bf16 v[88:91], v[20:23], v[124:127], v[88:91]
ds_read_b128 v[124:127], v150 offset:14336
s_waitcnt lgkmcnt(9)
v_mfma_f32_16x16x32_bf16 v[56:59], v[16:19], v[128:131], v[56:59]
v_mfma_f32_16x16x32_bf16 v[92:95], v[20:23], v[128:131], v[92:95]
ds_read_b128 v[128:131], v150 offset:16384
s_waitcnt lgkmcnt(9)
v_mfma_f32_16x16x32_bf16 v[60:63], v[16:19], v[132:135], v[60:63]
v_mfma_f32_16x16x32_bf16 v[96:99], v[20:23], v[132:135], v[96:99]
ds_read_b128 v[132:135], v151
s_waitcnt lgkmcnt(9)
v_mfma_f32_16x16x32_bf16 v[64:67], v[16:19], v[136:139], v[64:67]
v_mfma_f32_16x16x32_bf16 v[100:103], v[20:23], v[136:139], v[100:103]
ds_read_b128 v[136:139], v151 offset:2048
s_waitcnt lgkmcnt(5)
v_mfma_f32_16x16x32_bf16 v[68:71], v[16:19], v[140:143], v[68:71]
v_mfma_f32_16x16x32_bf16 v[104:107], v[20:23], v[140:143], v[104:107]
ds_read_b128 v[140:143], v151 offset:4096
s_waitcnt lgkmcnt(5)
v_mfma_f32_16x16x32_bf16 v[72:75], v[16:19], v[120:123], v[72:75]
v_mfma_f32_16x16x32_bf16 v[108:111], v[20:23], v[120:123], v[108:111]
ds_read_b128 v[120:123], v151 offset:6144
s_waitcnt lgkmcnt(5)
v_mfma_f32_16x16x32_bf16 v[76:79], v[16:19], v[124:127], v[76:79]
v_mfma_f32_16x16x32_bf16 v[112:115], v[20:23], v[124:127], v[112:115]
ds_read_b128 v[124:127], v151 offset:8192
s_waitcnt lgkmcnt(5)
v_mfma_f32_16x16x32_bf16 v[80:83], v[16:19], v[128:131], v[80:83]
v_mfma_f32_16x16x32_bf16 v[116:119], v[20:23], v[128:131], v[116:119]
L_q820:
s_waitcnt vmcnt(8)
s_barrier
s_cmp_ge_u32 s3, 8
s_cbranch_scc1 L_q821
ds_read_b128 v[128:131], v151 offset:10240
s_waitcnt lgkmcnt(5)
v_mfma_f32_16x16x32_bf16 v[48:51], v[24:27], v[132:135], v[48:51]
v_mfma_f32_16x16x32_bf16 v[84:87], v[28:31], v[132:135], v[84:87]
ds_read_b128 v[132:135], v151 offset:12288
s_waitcnt lgkmcnt(5)
v_mfma_f32_16x16x32_bf16 v[52:55], v[24:27], v[136:139], v[52:55]
v_mfma_f32_16x16x32_bf16 v[88:91], v[28:31], v[136:139], v[88:91]
ds_read_b128 v[136:139], v151 offset:14336
s_waitcnt lgkmcnt(5)
v_mfma_f32_16x16x32_bf16 v[56:59], v[24:27], v[140:143], v[56:59]
v_mfma_f32_16x16x32_bf16 v[92:95], v[28:31], v[140:143], v[92:95]
ds_read_b128 v[140:143], v151 offset:16384
s_waitcnt lgkmcnt(5)
v_mfma_f32_16x16x32_bf16 v[60:63], v[24:27], v[120:123], v[60:63]
v_mfma_f32_16x16x32_bf16 v[96:99], v[28:31], v[120:123], v[96:99]
s_waitcnt lgkmcnt(4)
v_mfma_f32_16x16x32_bf16 v[64:67], v[24:27], v[124:127], v[64:67]
v_mfma_f32_16x16x32_bf16 v[100:103], v[28:31], v[124:127], v[100:103]
s_waitcnt lgkmcnt(3)
v_mfma_f32_16x16x32_bf16 v[68:71], v[24:27], v[128:131], v[68:71]
v_mfma_f32_16x16x32_bf16 v[104:107], v[28:31], v[128:131], v[104:107]
s_waitcnt lgkmcnt(2)
v_mfma_f32_16x16x32_bf16 v[72:75], v[24:27], v[132:135], v[72:75]
v_mfma_f32_16x16x32_bf16 v[108:111], v[28:31], v[132:135], v[108:111]
s_waitcnt lgkmcnt(1)
v_mfma_f32_16x16x32_bf16 v[76:79], v[24:27], v[136:139], v[76:79]
v_mfma_f32_16x16x32_bf16 v[112:115], v[28:31], v[136:139], v[112:115]
s_waitcnt lgkmcnt(0)
v_mfma_f32_16x16x32_bf16 v[80:83], v[24:27], v[140:143], v[80:83]
v_mfma_f32_16x16x32_bf16 v[116:119], v[28:31], v[140:143], v[116:119]
L_q821:
s_waitcnt lgkmcnt(0)
s_barrier
s_cmp_ge_u32 s3, 8
s_cbranch_scc1 L_q8b22
s_nop 7
v_cvt_pk_bf16_f32 v120, v48, v49
v_cvt_pk_bf16_f32 v121, v50, v51
ds_write_b64 v164, v[120:121]
v_cvt_pk_bf16_f32 v122, v84, v85
v_cvt_pk_bf16_f32 v123, v86, v87
ds_write_b64 v164, v[122:123] offset:512
v_cvt_pk_bf16_f32 v120, v52, v53
v_cvt_pk_bf16_f32 v121, v54, v55
ds_write_b64 v164, v[120:121] offset:8192
v_cvt_pk_bf16_f32 v122, v88, v89
v_cvt_pk_bf16_f32 v123, v90, v91
ds_write_b64 v164, v[122:123] offset:8704
v_cvt_pk_bf16_f32 v120, v56, v57
v_cvt_pk_bf16_f32 v121, v58, v59
ds_write_b64 v164, v[120:121] offset:16384
v_cvt_pk_bf16_f32 v122, v92, v93
v_cvt_pk_bf16_f32 v123, v94, v95
ds_write_b64 v164, v[122:123] offset:16896
v_cvt_pk_bf16_f32 v120, v60, v61
v_cvt_pk_bf16_f32 v121, v62, v63
ds_write_b64 v164, v[120:121] offset:24576
v_cvt_pk_bf16_f32 v122, v96, v97
v_cvt_pk_bf16_f32 v123, v98, v99
ds_write_b64 v164, v[122:123] offset:25088
v_cvt_pk_bf16_f32 v120, v64, v65
v_cvt_pk_bf16_f32 v121, v66, v67
ds_write_b64 v164, v[120:121] offset:32768
v_cvt_pk_bf16_f32 v122, v100, v101
v_cvt_pk_bf16_f32 v123, v102, v103
ds_write_b64 v164, v[122:123] offset:33280
v_cvt_pk_bf16_f32 v120, v68, v69
v_cvt_pk_bf16_f32 v121, v70, v71
ds_write_b64 v164, v[120:121] offset:40960
v_cvt_pk_bf16_f32 v122, v104, v105
v_cvt_pk_bf16_f32 v123, v106, v107
ds_write_b64 v164, v[122:123] offset:41472
v_cvt_pk_bf16_f32 v120, v72, v73
v_cvt_pk_bf16_f32 v121, v74, v75
ds_write_b64 v164, v[120:121] offset:49152
v_cvt_pk_bf16_f32 v122, v108, v109
v_cvt_pk_bf16_f32 v123, v110, v111
ds_write_b64 v164, v[122:123] offset:49664
v_cvt_pk_bf16_f32 v120, v76, v77
v_cvt_pk_bf16_f32 v121, v78, v79
ds_write_b64 v164, v[120:121] offset:57344
v_cvt_pk_bf16_f32 v122, v112, v113
v_cvt_pk_bf16_f32 v123, v114, v115
ds_write_b64 v164, v[122:123] offset:57856
v_cvt_pk_bf16_f32 v120, v80, v81
v_cvt_pk_bf16_f32 v121, v82, v83
ds_write_b64 v166, v[120:121]
v_cvt_pk_bf16_f32 v122, v116, v117
v_cvt_pk_bf16_f32 v123, v118, v119
ds_write_b64 v166, v[122:123] offset:512
L_q8b22:
s_waitcnt lgkmcnt(0)
s_barrier
ds_read_b128 v[16:19], v165
ds_read_b128 v[20:23], v165 offset:1024
ds_read_b128 v[24:27], v165 offset:2048
ds_read_b128 v[28:31], v165 offset:3072
ds_read_b128 v[32:35], v165 offset:4096
ds_read_b128 v[36:39], v165 offset:5120
ds_read_b128 v[40:43], v165 offset:6144
ds_read_b128 v[44:47], v165 offset:7168
s_waitcnt lgkmcnt(0)
v_xor_b32 v163, 192, v160
v_xor_b32 v162, 128, v160
v_xor_b32 v161, 64, v160
v_xor_b32 v160, 0, v160
v_mov_b32 v144, 0x3f803f80
v_mov_b32 v145, 0x3f803f80
v_mov_b32 v146, 0x3f803f80
v_mov_b32 v147, 0x3f803f80
v_add_u32 v156, 16384, v154
v_add_u32 v157, 16384, v155
v_lshlrev_b32 v158, 1, v6
s_mov_b32 s78, 0x427af233
s_mov_b32 s79, 0
s_mov_b32 s80, 0
s_mov_b32 s95, 0
s_nop 7
s_nop 7
L_item23:
v_mov_b32 v152, 0xf149f2ca
v_mov_b32 v164, 0
v_mov_b32 v165, 0
v_mov_b32 v166, 0
v_mov_b32 v167, 0
v_mov_b32 v48, 0
v_mov_b32 v49, 0
v_mov_b32 v50, 0
v_mov_b32 v51, 0
v_mov_b32 v52, 0
v_mov_b32 v53, 0
v_mov_b32 v54, 0
v_mov_b32 v55, 0
v_mov_b32 v56, 0
v_mov_b32 v57, 0
v_mov_b32 v58, 0
v_mov_b32 v59, 0
v_mov_b32 v60, 0
v_mov_b32 v61, 0
v_mov_b32 v62, 0
v_mov_b32 v63, 0
v_mov_b32 v64, 0
v_mov_b32 v65, 0
v_mov_b32 v66, 0
v_mov_b32 v67, 0
v_mov_b32 v68, 0
v_mov_b32 v69, 0
v_mov_b32 v70, 0
v_mov_b32 v71, 0
v_mov_b32 v72, 0
v_mov_b32 v73, 0
v_mov_b32 v74, 0
v_mov_b32 v75, 0
v_mov_b32 v76, 0
v_mov_b32 v77, 0
v_mov_b32 v78, 0
v_mov_b32 v79, 0
s_mov_b32 s96, 0
s_nop 7
s_nop 7
L_chunk24:
s_waitcnt vmcnt(4) lgkmcnt(0)
s_barrier
ds_read_b128 v[104:107], v160
ds_read_b128 v[108:111], v161
ds_read_b128 v[112:115], v162
ds_read_b128 v[116:119], v163
ds_read_b128 v[120:123], v160 offset:4096
ds_read_b128 v[124:127], v161 offset:4096
ds_read_b128 v[128:131], v162 offset:4096
ds_read_b128 v[132:135], v163 offset:4096
s_cmp_ge_u32 s3, 8
s_cbranch_scc1 L_nodma25
s_add_u32 s97, s79, 2
s_lshl_b32 s97, s97, 14
s_add_u32 s94, s80, 65536
s_sub_u32 s82, s94, 98304
s_cmp_ge_u32 s94, 98304
s_cselect_b32 s94, s82, s94
s_add_u32 s83, s94, s76
s_add_u32 s81, s97, s76
s_add_u32 m0, s83, 0
s_add_u32 s82, s81, 0
buffer_load_dwordx4 v10, s[48:51], s82 offen nt lds
s_add_u32 m0, s83, 1024
s_add_u32 s82, s81, 1024
buffer_load_dwordx4 v11, s[48:51], s82 offen nt lds
s_add_u32 m0, s83, 16384
s_add_u32 s82, s81, 0
buffer_load_dwordx4 v12, s[52:55], s82 offen nt lds
s_add_u32 m0, s83, 17408
s_add_u32 s82, s81, 1024
buffer_load_dwordx4 v13, s[52:55], s82 offen nt lds
L_nodma25:
s_waitcnt lgkmcnt(4)
v_mfma_f32_16x16x32_bf16 v[80:83], v[104:107], v[16:19], 0
v_mfma_f32_16x16x32_bf16 v[80:83], v[108:111], v[20:23], v[80:83]
v_mfma_f32_16x16x32_bf16 v[80:83], v[112:115], v[24:27], v[80:83]
v_mfma_f32_16x16x32_bf16 v[80:83], v[116:119], v[28:31], v[80:83]
ds_read_b128 v[104:107], v160 offset:8192
ds_read_b128 v[108:111], v161 offset:8192
ds_read_b128 v[112:115], v162 offset:8192
ds_read_b128 v[116:119], v163 offset:8192
s_waitcnt lgkmcnt(4)
v_mfma_f32_16x16x32_bf16 v[84:87], v[120:123], v[16:19], 0
v_mfma_f32_16x16x32_bf16 v[84:87], v[124:127], v[20:23], v[84:87]
v_mfma_f32_16x16x32_bf16 v[84:87], v[128:131], v[24:27], v[84:87]
v_mfma_f32_16x16x32_bf16 v[84:87], v[132:135], v[28:31], v[84:87]
ds_read_b128 v[120:123], v160 offset:12288
ds_read_b128 v[124:127], v161 offset:12288
ds_read_b128 v[128:131], v162 offset:12288
ds_read_b128 v[132:135], v163 offset:12288
s_waitcnt lgkmcnt(4)
v_mfma_f32_16x16x32_bf16 v[88:91], v[104:107], v[16:19], 0
v_mfma_f32_16x16x32_bf16 v[88:91], v[108:111], v[20:23], v[88:91]
v_mfma_f32_16x16x32_bf16 v[88:91], v[112:115], v[24:27], v[88:91]
v_mfma_f32_16x16x32_bf16 v[88:91], v[116:119], v[28:31], v[88:91]
s_waitcnt lgkmcnt(0)
v_mfma_f32_16x16x32_bf16 v[92:95], v[120:123], v[16:19], 0
v_mfma_f32_16x16x32_bf16 v[92:95], v[124:127], v[20:23], v[92:95]
v_mfma_f32_16x16x32_bf16 v[92:95], v[128:131], v[24:27], v[92:95]
v_mfma_f32_16x16x32_bf16 v[92:95], v[132:135], v[28:31], v[92:95]
ds_read_b64_tr_b16 v[136:137], v156 offset:0
ds_read_b64_tr_b16 v[138:139], v156 offset:4096
ds_read_b64_tr_b16 v[140:141], v157 offset:128
ds_read_b64_tr_b16 v[142:143], v157 offset:4224
ds_read_b64_tr_b16 v[104:105], v156 offset:256
ds_read_b64_tr_b16 v[106:107], v156 offset:4352
ds_read_b64_tr_b16 v[108:109], v157 offset:384
ds_read_b64_tr_b16 v[110:111], v157 offset:4480
ds_read_b64_tr_b16 v[112:113], v156 offset:512
ds_read_b64_tr_b16 v[114:115], v156 offset:4608
ds_read_b64_tr_b16 v[116:117], v157 offset:640
ds_read_b64_tr_b16 v[118:119], v157 offset:4736
ds_read_b64_tr_b16 v[120:121], v156 offset:768
ds_read_b64_tr_b16 v[122:123], v156 offset:4864
ds_read_b64_tr_b16 v[124:125], v157 offset:896
ds_read_b64_tr_b16 v[126:127], v157 offset:4992
ds_read_b64_tr_b16 v[128:129], v156 offset:8192
ds_read_b64_tr_b16 v[130:131], v156 offset:12288
v_max3_f32 v7, v80, v81, v82
v_max3_f32 v7, v7, v83, v84
v_max3_f32 v7, v7, v85, v86
v_max3_f32 v7, v7, v87, v88
v_max3_f32 v7, v7, v89, v90
v_max3_f32 v7, v7, v91, v92
v_max3_f32 v7, v7, v93, v94
v_max_f32 v7, v7, v95
v_sub_f32 v8, v7, v152
v_cmp_lt_f32 vcc, s78, v8
s_nop 1
s_cbranch_vccz L_nors26
v_max_f32 v7, v7, v152
v_mov_b32 v8, v7
s_nop 1
v_permlane32_swap_b32 v7, v8
v_max_f32 v7, v7, v8
v_mov_b32 v8, v7
s_nop 1
v_permlane16_swap_b32 v7, v8
v_max_f32 v7, v7, v8
v_sub_f32 v9, v152, v7
v_mul_f32 v9, s10, v9
v_exp_f32 v9, v9
v_mul_f32 v5, s10, v7
v_mov_b32 v152, v7
v_mul_f32 v164, v164, v9
v_mul_f32 v48, v48, v9
v_mul_f32 v49, v49, v9
v_mul_f32 v50, v50, v9
v_mul_f32 v51, v51, v9
v_mul_f32 v52, v52, v9
v_mul_f32 v53, v53, v9
v_mul_f32 v54, v54, v9
v_mul_f32 v55, v55, v9
v_mul_f32 v56, v56, v9
v_mul_f32 v57, v57, v9
v_mul_f32 v58, v58, v9
v_mul_f32 v59, v59, v9
v_mul_f32 v60, v60, v9
v_mul_f32 v61, v61, v9
v_mul_f32 v62, v62, v9
v_mul_f32 v63, v63, v9
v_mul_f32 v64, v64, v9
v_mul_f32 v65, v65, v9
v_mul_f32 v66, v66, v9
v_mul_f32 v67, v67, v9
v_mul_f32 v68, v68, v9
v_mul_f32 v69, v69, v9
v_mul_f32 v70, v70, v9
v_mul_f32 v71, v71, v9
v_mul_f32 v72, v72, v9
v_mul_f32 v73, v73, v9
v_mul_f32 v74, v74, v9
v_mul_f32 v75, v75, v9
v_mul_f32 v76, v76, v9
v_mul_f32 v77, v77, v9
v_mul_f32 v78, v78, v9
v_mul_f32 v79, v79, v9
s_nop 1
L_nors26:
v_fma_f32 v80, v80, s10, -v5
v_fma_f32 v81, v81, s10, -v5
v_exp_f32 v80, v80
v_exp_f32 v81, v81
s_nop 0
v_cvt_pk_bf16_f32 v96, v80, v81
v_fma_f32 v82, v82, s10, -v5
v_fma_f32 v83, v83, s10, -v5
v_exp_f32 v82, v82
v_exp_f32 v83, v83
s_nop 0
v_cvt_pk_bf16_f32 v97, v82, v83
v_fma_f32 v84, v84, s10, -v5
v_fma_f32 v85, v85, s10, -v5
v_exp_f32 v84, v84
v_exp_f32 v85, v85
s_nop 0
v_cvt_pk_bf16_f32 v98, v84, v85
v_fma_f32 v86, v86, s10, -v5
v_fma_f32 v87, v87, s10, -v5
v_exp_f32 v86, v86
v_exp_f32 v87, v87
s_nop 0
v_cvt_pk_bf16_f32 v99, v86, v87
v_fma_f32 v88, v88, s10, -v5
v_fma_f32 v89, v89, s10, -v5
v_exp_f32 v88, v88
v_exp_f32 v89, v89
s_nop 0
v_cvt_pk_bf16_f32 v100, v88, v89
v_fma_f32 v90, v90, s10, -v5
v_fma_f32 v91, v91, s10, -v5
v_exp_f32 v90, v90
v_exp_f32 v91, v91
s_nop 0
v_cvt_pk_bf16_f32 v101, v90, v91
v_fma_f32 v92, v92, s10, -v5
v_fma_f32 v93, v93, s10, -v5
v_exp_f32 v92, v92
v_exp_f32 v93, v93
s_nop 0
v_cvt_pk_bf16_f32 v102, v92, v93
v_fma_f32 v94, v94, s10, -v5
v_fma_f32 v95, v95, s10, -v5
v_exp_f32 v94, v94
v_exp_f32 v95, v95
s_nop 0
v_cvt_pk_bf16_f32 v103, v94, v95
ds_read_b64_tr_b16 v[132:133], v157 offset:8320
ds_read_b64_tr_b16 v[134:135], v157 offset:12416
s_waitcnt lgkmcnt(15)
v_mfma_f32_16x16x32_bf16 v[164:167], v[144:147], v[96:99], v[164:167]
v_mfma_f32_16x16x32_bf16 v[48:51], v[136:139], v[96:99], v[48:51]
ds_read_b64_tr_b16 v[136:137], v156 offset:8448
ds_read_b64_tr_b16 v[138:139], v156 offset:12544
v_mfma_f32_16x16x32_bf16 v[52:55], v[140:143], v[96:99], v[52:55]
ds_read_b64_tr_b16 v[140:141], v157 offset:8576
ds_read_b64_tr_b16 v[142:143], v157 offset:12672
s_waitcnt lgkmcnt(15)
v_mfma_f32_16x16x32_bf16 v[56:59], v[104:107], v[96:99], v[56:59]
ds_read_b64_tr_b16 v[104:105], v156 offset:8704
ds_read_b64_tr_b16 v[106:107], v156 offset:12800
v_mfma_f32_16x16x32_bf16 v[60:63], v[108:111], v[96:99], v[60:63]
ds_read_b64_tr_b16 v[108:109], v157 offset:8832
ds_read_b64_tr_b16 v[110:111], v157 offset:12928
s_waitcnt lgkmcnt(15)
v_mfma_f32_16x16x32_bf16 v[64:67], v[112:115], v[96:99], v[64:67]
ds_read_b64_tr_b16 v[112:113], v156 offset:8960
ds_read_b64_tr_b16 v[114:115], v156 offset:13056
v_mfma_f32_16x16x32_bf16 v[68:71], v[116:119], v[96:99], v[68:71]
ds_read_b64_tr_b16 v[116:117], v157 offset:9088
ds_read_b64_tr_b16 v[118:119], v157 offset:13184
s_waitcnt lgkmcnt(15)
v_mfma_f32_16x16x32_bf16 v[72:75], v[120:123], v[96:99], v[72:75]
v_mfma_f32_16x16x32_bf16 v[76:79], v[124:127], v[96:99], v[76:79]
s_waitcnt lgkmcnt(12)
v_mfma_f32_16x16x32_bf16 v[164:167], v[144:147], v[100:103], v[164:167]
v_mfma_f32_16x16x32_bf16 v[48:51], v[128:131], v[100:103], v[48:51]
v_mfma_f32_16x16x32_bf16 v[52:55], v[132:135], v[100:103], v[52:55]
s_waitcnt lgkmcnt(8)
v_mfma_f32_16x16x32_bf16 v[56:59], v[136:139], v[100:103], v[56:59]
v_mfma_f32_16x16x32_bf16 v[60:63], v[140:143], v[100:103], v[60:63]
s_waitcnt lgkmcnt(4)
v_mfma_f32_16x16x32_bf16 v[64:67], v[104:107], v[100:103], v[64:67]
v_mfma_f32_16x16x32_bf16 v[68:71], v[108:111], v[100:103], v[68:71]
s_waitcnt lgkmcnt(0)
v_mfma_f32_16x16x32_bf16 v[72:75], v[112:115], v[100:103], v[72:75]
v_mfma_f32_16x16x32_bf16 v[76:79], v[116:119], v[100:103], v[76:79]
s_add_u32 s97, s80, 32768
s_sub_u32 s82, s97, 98304
s_cmp_ge_u32 s97, 98304
s_cselect_b32 s97, s82, s97
s_sub_u32 s94, s97, s80
s_mov_b32 s80, s97
v_add_u32 v160, s94, v160
v_add_u32 v161, s94, v161
v_add_u32 v162, s94, v162
v_add_u32 v163, s94, v163
v_add_u32 v156, s94, v156
v_add_u32 v157, s94, v157
s_add_u32 s79, s79, 1
s_add_u32 s96, s96, 1
s_nop 7
s_cmp_lt_u32 s96, 8
s_cbranch_scc1 L_chunk24
s_nop 7
v_rcp_f32 v9, v164
s_nop 0
v_mul_f32 v48, v48, v9
v_mul_f32 v49, v49, v9
v_mul_f32 v50, v50, v9
v_mul_f32 v51, v51, v9
v_mul_f32 v52, v52, v9
v_mul_f32 v53, v53, v9
v_mul_f32 v54, v54, v9
v_mul_f32 v55, v55, v9
v_mul_f32 v56, v56, v9
v_mul_f32 v57, v57, v9
v_mul_f32 v58, v58, v9
v_mul_f32 v59, v59, v9
v_mul_f32 v60, v60, v9
v_mul_f32 v61, v61, v9
v_mul_f32 v62, v62, v9
v_mul_f32 v63, v63, v9
v_mul_f32 v64, v64, v9
v_mul_f32 v65, v65, v9
v_mul_f32 v66, v66, v9
v_mul_f32 v67, v67, v9
v_mul_f32 v68, v68, v9
v_mul_f32 v69, v69, v9
v_mul_f32 v70, v70, v9
v_mul_f32 v71, v71, v9
v_mul_f32 v72, v72, v9
v_mul_f32 v73, v73, v9
v_mul_f32 v74, v74, v9
v_mul_f32 v75, v75, v9
v_mul_f32 v76, v76, v9
v_mul_f32 v77, v77, v9
v_mul_f32 v78, v78, v9
v_mul_f32 v79, v79, v9
v_cvt_pk_bf16_f32 v104, v48, v49
v_cvt_pk_bf16_f32 v105, v50, v51
v_cvt_pk_bf16_f32 v106, v52, v53
v_cvt_pk_bf16_f32 v107, v54, v55
v_cvt_pk_bf16_f32 v108, v56, v57
v_cvt_pk_bf16_f32 v109, v58, v59
v_cvt_pk_bf16_f32 v110, v60, v61
v_cvt_pk_bf16_f32 v111, v62, v63
v_cvt_pk_bf16_f32 v112, v64, v65
v_cvt_pk_bf16_f32 v113, v66, v67
v_cvt_pk_bf16_f32 v114, v68, v69
v_cvt_pk_bf16_f32 v115, v70, v71
v_cvt_pk_bf16_f32 v116, v72, v73
v_cvt_pk_bf16_f32 v117, v74, v75
v_cvt_pk_bf16_f32 v118, v76, v77
v_cvt_pk_bf16_f32 v119, v78, v79
s_lshl_b32 s81, s3, 17
s_add_u32 s81, s81, s72
s_lshl_b32 s82, s95, 12
s_add_u32 s81, s81, s82
buffer_store_dwordx4 v[104:107], v158, s[60:63], s81 offen sc0 sc1
buffer_store_dwordx4 v[108:111], v158, s[60:63], s81 offen offset:1024 sc0 sc1
buffer_store_dwordx4 v[112:115], v158, s[60:63], s81 offen offset:2048 sc0 sc1
buffer_store_dwordx4 v[116:119], v158, s[60:63], s81 offen offset:3072 sc0 sc1
v_mov_b32 v16, v32
v_mov_b32 v17, v33
v_mov_b32 v18, v34
v_mov_b32 v19, v35
v_mov_b32 v20, v36
v_mov_b32 v21, v37
v_mov_b32 v22, v38
v_mov_b32 v23, v39
v_mov_b32 v24, v40
v_mov_b32 v25, v41
v_mov_b32 v26, v42
v_mov_b32 v27, v43
v_mov_b32 v28, v44
v_mov_b32 v29, v45
v_mov_b32 v30, v46
v_mov_b32 v31, v47
s_add_u32 s95, s95, 1
s_cmp_lt_u32 s95, 2
s_cbranch_scc1 L_item23
s_nop 7
s_nop 7
L_attn_end:
s_endpgm
.p2align 8
oproj_kernel:
s_cmp_ge_u32 s2, 240
s_cbranch_scc1 L_oproj_end
s_load_dwordx16 s[16:31], s[0:1], 0
s_load_dwordx8 s[32:39], s[0:1], 64
s_load_dwordx2 s[40:41], s[0:1], 96
s_and_b32 s7, s2, 7
s_lshr_b32 s8, s2, 3
s_lshr_b32 s4, s7, 2
s_mul_i32 s9, s8, 205
s_lshr_b32 s9, s9, 10
s_and_b32 s13, s7, 3
s_mul_i32 s13, s13, 6
s_add_u32 s5, s13, s9
s_mul_i32 s9, s9, 5
s_sub_u32 s6, s8, s9
s_mov_b32 s75, s8
s_mov_b32 s11, 0x05040100
s_mov_b32 s12, 0x07060302
v_and_b32 v1, 63, v0
v_and_b32 v2, 15, v0
v_lshrrev_b32 v3, 4, v1
v_lshrrev_b32 v4, 6, v0
s_nop 0
v_readfirstlane_b32 s3, v4
s_waitcnt lgkmcnt(0)
s_cmp_eq_u32 s4, 0
s_cselect_b64 s[64:65], s[24:25], s[34:35]
s_mov_b32 s48, s64
s_and_b32 s49, s65, 0xffff
s_mov_b32 s50, 5242880
s_mov_b32 s51, 0x20000
s_mul_i32 s7, s4, 9437184
s_add_u32 s8, s40, s7
s_addc_u32 s9, s41, 0
s_mov_b32 s44, s8
s_and_b32 s45, s9, 0xffff
s_mov_b32 s46, 9437184
s_mov_b32 s47, 0x20000
s_mov_b32 s52, s36
s_and_b32 s53, s37, 0xffff
s_mov_b32 s54, 2949120
s_mov_b32 s55, 0x20000
s_mul_i32 s7, s5, 384
s_lshl_b32 s8, s3, 5
s_add_u32 s7, s7, s8
s_lshl_b32 s72, s7, 10
s_mul_i32 s7, s3, 1310720
s_lshl_b32 s8, s6, 8
s_add_u32 s73, s7, s8
v_lshlrev_b32 v15, 4, v1
v_add_u32 v5, 0, v15
v_add_u32 v6, 131072, v15
v_add_u32 v7, 262144, v15
v_mul_u32_u24 v16, 5120, v3
v_lshl_add_u32 v11, v2, 4, v16
v_add_u32 v12, 20480, v11
v_mul_u32_u24 v16, 24576, v4
v_add_u32 v18, v16, v15
v_lshl_add_u32 v19, v4, 13, v15
v_add_u32 v21, 49152, v19
s_mul_i32 s7, s5, 122880
s_mul_i32 s8, s4, 1280
s_add_u32 s7, s7, s8
s_lshl_b32 s8, s6, 8
s_add_u32 s74, s7, s8
v_lshl_add_u32 v16, v4, 4, v2
v_mul_u32_u24 v16, 2560, v16
v_lshl_add_u32 v20, v3, 6, v16
s_add_u32 s92, s75, 0
s_and_b32 s92, s92, 7
s_add_u32 s92, s92, 0
s_lshl_b32 s93, s92, 10
s_add_u32 s76, s72, s93
buffer_load_dwordx4 a[96:99], v5, s[44:47], s76 offen
buffer_load_dwordx4 a[100:103], v6, s[44:47], s76 offen
buffer_load_dwordx4 a[104:107], v7, s[44:47], s76 offen
s_mul_i32 s93, s92, 40960
s_add_u32 s77, s73, s93
buffer_load_dwordx4 v[32:35], v11, s[48:51], s77 offen
buffer_load_dwordx4 v[36:39], v11, s[48:51], s77 offen offset:1280
buffer_load_dwordx4 v[40:43], v11, s[48:51], s77 offen offset:2560
buffer_load_dwordx4 v[44:47], v11, s[48:51], s77 offen offset:3840
buffer_load_dwordx4 v[48:51], v12, s[48:51], s77 offen
buffer_load_dwordx4 v[52:55], v12, s[48:51], s77 offen offset:1280
buffer_load_dwordx4 v[56:59], v12, s[48:51], s77 offen offset:2560
buffer_load_dwordx4 v[60:63], v12, s[48:51], s77 offen offset:3840
s_add_u32 s92, s75, 1
s_and_b32 s92, s92, 7
s_add_u32 s92, s92, 0
s_lshl_b32 s93, s92, 10
s_add_u32 s78, s72, s93
buffer_load_dwordx4 a[108:111], v5, s[44:47], s78 offen
buffer_load_dwordx4 a[112:115], v6, s[44:47], s78 offen
buffer_load_dwordx4 a[116:119], v7, s[44:47], s78 offen
s_mul_i32 s93, s92, 40960
s_add_u32 s79, s73, s93
buffer_load_dwordx4 v[64:67], v11, s[48:51], s79 offen
buffer_load_dwordx4 v[68:71], v11, s[48:51], s79 offen offset:1280
buffer_load_dwordx4 v[72:75], v11, s[48:51], s79 offen offset:2560
buffer_load_dwordx4 v[76:79], v11, s[48:51], s79 offen offset:3840
buffer_load_dwordx4 v[80:83], v12, s[48:51], s79 offen
buffer_load_dwordx4 v[84:87], v12, s[48:51], s79 offen offset:1280
buffer_load_dwordx4 v[88:91], v12, s[48:51], s79 offen offset:2560
buffer_load_dwordx4 v[92:95], v12, s[48:51], s79 offen offset:3840
s_add_u32 s92, s75, 2
s_and_b32 s92, s92, 7
s_add_u32 s92, s92, 0
s_lshl_b32 s93, s92, 10
s_add_u32 s80, s72, s93
buffer_load_dwordx4 a[120:123], v5, s[44:47], s80 offen
buffer_load_dwordx4 a[124:127], v6, s[44:47], s80 offen
buffer_load_dwordx4 a[128:131], v7, s[44:47], s80 offen
s_mul_i32 s93, s92, 40960
s_add_u32 s81, s73, s93
buffer_load_dwordx4 v[96:99], v11, s[48:51], s81 offen
buffer_load_dwordx4 v[100:103], v11, s[48:51], s81 offen offset:1280
buffer_load_dwordx4 v[104:107], v11, s[48:51], s81 offen offset:2560
buffer_load_dwordx4 v[108:111], v11, s[48:51], s81 offen offset:3840
buffer_load_dwordx4 v[112:115], v12, s[48:51], s81 offen
buffer_load_dwordx4 v[116:119], v12, s[48:51], s81 offen offset:1280
buffer_load_dwordx4 v[120:123], v12, s[48:51], s81 offen offset:2560
buffer_load_dwordx4 v[124:127], v12, s[48:51], s81 offen offset:3840
s_add_u32 s92, s75, 3
s_and_b32 s92, s92, 7
s_add_u32 s92, s92, 0
s_lshl_b32 s93, s92, 10
s_add_u32 s82, s72, s93
buffer_load_dwordx4 a[132:135], v5, s[44:47], s82 offen
buffer_load_dwordx4 a[136:139], v6, s[44:47], s82 offen
buffer_load_dwordx4 a[140:143], v7, s[44:47], s82 offen
s_mul_i32 s93, s92, 40960
s_add_u32 s83, s73, s93
buffer_load_dwordx4 v[128:131], v11, s[48:51], s83 offen
buffer_load_dwordx4 v[132:135], v11, s[48:51], s83 offen offset:1280
buffer_load_dwordx4 v[136:139], v11, s[48:51], s83 offen offset:2560
buffer_load_dwordx4 v[140:143], v11, s[48:51], s83 offen offset:3840
buffer_load_dwordx4 v[144:147], v12, s[48:51], s83 offen
buffer_load_dwordx4 v[148:151], v12, s[48:51], s83 offen offset:1280
buffer_load_dwordx4 v[152:155], v12, s[48:51], s83 offen offset:2560
buffer_load_dwordx4 v[156:159], v12, s[48:51], s83 offen offset:3840
s_add_u32 s92, s75, 4
s_and_b32 s92, s92, 7
s_add_u32 s92, s92, 0
s_lshl_b32 s93, s92, 10
s_add_u32 s76, s72, s93
buffer_load_dwordx4 a[144:147], v5, s[44:47], s76 offen
buffer_load_dwordx4 a[148:151], v6, s[44:47], s76 offen
buffer_load_dwordx4 a[152:155], v7, s[44:47], s76 offen
s_mul_i32 s93, s92, 40960
s_add_u32 s77, s73, s93
buffer_load_dwordx4 v[160:163], v11, s[48:51], s77 offen
buffer_load_dwordx4 v[164:167], v11, s[48:51], s77 offen offset:1280
buffer_load_dwordx4 v[168:171], v11, s[48:51], s77 offen offset:2560
buffer_load_dwordx4 v[172:175], v11, s[48:51], s77 offen offset:3840
buffer_load_dwordx4 v[176:179], v12, s[48:51], s77 offen
buffer_load_dwordx4 v[180:183], v12, s[48:51], s77 offen offset:1280
buffer_load_dwordx4 v[184:187], v12, s[48:51], s77 offen offset:2560
buffer_load_dwordx4 v[188:191], v12, s[48:51], s77 offen offset:3840
s_waitcnt vmcnt(44)
v_perm_b32 v192, v36, v32, s11
v_perm_b32 v193, v44, v40, s11
v_perm_b32 v194, v52, v48, s11
v_perm_b32 v195, v60, v56, s11
v_perm_b32 v196, v36, v32, s12
v_perm_b32 v197, v44, v40, s12
v_perm_b32 v198, v52, v48, s12
v_perm_b32 v199, v60, v56, s12
v_perm_b32 v200, v37, v33, s11
v_perm_b32 v201, v45, v41, s11
v_perm_b32 v202, v53, v49, s11
v_perm_b32 v203, v61, v57, s11
v_perm_b32 v204, v37, v33, s12
v_perm_b32 v205, v45, v41, s12
v_perm_b32 v206, v53, v49, s12
v_perm_b32 v207, v61, v57, s12
v_perm_b32 v208, v38, v34, s11
v_perm_b32 v209, v46, v42, s11
v_perm_b32 v210, v54, v50, s11
v_perm_b32 v211, v62, v58, s11
v_perm_b32 v212, v38, v34, s12
v_perm_b32 v213, v46, v42, s12
v_perm_b32 v214, v54, v50, s12
v_perm_b32 v215, v62, v58, s12
v_perm_b32 v216, v39, v35, s11
v_perm_b32 v217, v47, v43, s11
v_perm_b32 v218, v55, v51, s11
v_perm_b32 v219, v63, v59, s11
v_perm_b32 v220, v39, v35, s12
v_perm_b32 v221, v47, v43, s12
v_perm_b32 v222, v55, v51, s12
v_perm_b32 v223, v63, v59, s12
v_mfma_f32_16x16x32_bf16 a[0:3], v[192:195], a[96:99], 0
v_mfma_f32_16x16x32_bf16 a[32:35], v[192:195], a[100:103], 0
v_mfma_f32_16x16x32_bf16 a[64:67], v[192:195], a[104:107], 0
v_mfma_f32_16x16x32_bf16 a[4:7], v[196:199], a[96:99], 0
v_mfma_f32_16x16x32_bf16 a[36:39], v[196:199], a[100:103], 0
v_mfma_f32_16x16x32_bf16 a[68:71], v[196:199], a[104:107], 0
v_mfma_f32_16x16x32_bf16 a[8:11], v[200:203], a[96:99], 0
v_mfma_f32_16x16x32_bf16 a[40:43], v[200:203], a[100:103], 0
v_mfma_f32_16x16x32_bf16 a[72:75], v[200:203], a[104:107], 0
v_mfma_f32_16x16x32_bf16 a[12:15], v[204:207], a[96:99], 0
v_mfma_f32_16x16x32_bf16 a[44:47], v[204:207], a[100:103], 0
v_mfma_f32_16x16x32_bf16 a[76:79], v[204:207], a[104:107], 0
v_mfma_f32_16x16x32_bf16 a[16:19], v[208:211], a[96:99], 0
v_mfma_f32_16x16x32_bf16 a[48:51], v[208:211], a[100:103], 0
v_mfma_f32_16x16x32_bf16 a[80:83], v[208:211], a[104:107], 0
v_mfma_f32_16x16x32_bf16 a[20:23], v[212:215], a[96:99], 0
v_mfma_f32_16x16x32_bf16 a[52:55], v[212:215], a[100:103], 0
v_mfma_f32_16x16x32_bf16 a[84:87], v[212:215], a[104:107], 0
v_mfma_f32_16x16x32_bf16 a[24:27], v[216:219], a[96:99], 0
v_mfma_f32_16x16x32_bf16 a[56:59], v[216:219], a[100:103], 0
v_mfma_f32_16x16x32_bf16 a[88:91], v[216:219], a[104:107], 0
v_mfma_f32_16x16x32_bf16 a[28:31], v[220:223], a[96:99], 0
v_mfma_f32_16x16x32_bf16 a[60:63], v[220:223], a[100:103], 0
v_mfma_f32_16x16x32_bf16 a[92:95], v[220:223], a[104:107], 0
s_add_u32 s92, s75, 5
s_and_b32 s92, s92, 7
s_add_u32 s92, s92, 0
s_lshl_b32 s93, s92, 10
s_add_u32 s78, s72, s93
buffer_load_dwordx4 a[96:99], v5, s[44:47], s78 offen
buffer_load_dwordx4 a[100:103], v6, s[44:47], s78 offen
buffer_load_dwordx4 a[104:107], v7, s[44:47], s78 offen
s_mul_i32 s93, s92, 40960
s_add_u32 s79, s73, s93
buffer_load_dwordx4 v[32:35], v11, s[48:51], s79 offen
buffer_load_dwordx4 v[36:39], v11, s[48:51], s79 offen offset:1280
buffer_load_dwordx4 v[40:43], v11, s[48:51], s79 offen offset:2560
buffer_load_dwordx4 v[44:47], v11, s[48:51], s79 offen offset:3840
buffer_load_dwordx4 v[48:51], v12, s[48:51], s79 offen
buffer_load_dwordx4 v[52:55], v12, s[48:51], s79 offen offset:1280
buffer_load_dwordx4 v[56:59], v12, s[48:51], s79 offen offset:2560
buffer_load_dwordx4 v[60:63], v12, s[48:51], s79 offen offset:3840
s_waitcnt vmcnt(44)
v_perm_b32 v192, v68, v64, s11
v_perm_b32 v193, v76, v72, s11
v_perm_b32 v194, v84, v80, s11
v_perm_b32 v195, v92, v88, s11
v_perm_b32 v196, v68, v64, s12
v_perm_b32 v197, v76, v72, s12
v_perm_b32 v198, v84, v80, s12
v_perm_b32 v199, v92, v88, s12
v_perm_b32 v200, v69, v65, s11
v_perm_b32 v201, v77, v73, s11
v_perm_b32 v202, v85, v81, s11
v_perm_b32 v203, v93, v89, s11
v_perm_b32 v204, v69, v65, s12
v_perm_b32 v205, v77, v73, s12
v_perm_b32 v206, v85, v81, s12
v_perm_b32 v207, v93, v89, s12
v_perm_b32 v208, v70, v66, s11
v_perm_b32 v209, v78, v74, s11
v_perm_b32 v210, v86, v82, s11
v_perm_b32 v211, v94, v90, s11
v_perm_b32 v212, v70, v66, s12
v_perm_b32 v213, v78, v74, s12
v_perm_b32 v214, v86, v82, s12
v_perm_b32 v215, v94, v90, s12
v_perm_b32 v216, v71, v67, s11
v_perm_b32 v217, v79, v75, s11
v_perm_b32 v218, v87, v83, s11
v_perm_b32 v219, v95, v91, s11
v_perm_b32 v220, v71, v67, s12
v_perm_b32 v221, v79, v75, s12
v_perm_b32 v222, v87, v83, s12
v_perm_b32 v223, v95, v91, s12
v_mfma_f32_16x16x32_bf16 a[0:3], v[192:195], a[108:111], a[0:3]
v_mfma_f32_16x16x32_bf16 a[32:35], v[192:195], a[112:115], a[32:35]
v_mfma_f32_16x16x32_bf16 a[64:67], v[192:195], a[116:119], a[64:67]
v_mfma_f32_16x16x32_bf16 a[4:7], v[196:199], a[108:111], a[4:7]
v_mfma_f32_16x16x32_bf16 a[36:39], v[196:199], a[112:115], a[36:39]
v_mfma_f32_16x16x32_bf16 a[68:71], v[196:199], a[116:119], a[68:71]
v_mfma_f32_16x16x32_bf16 a[8:11], v[200:203], a[108:111], a[8:11]
v_mfma_f32_16x16x32_bf16 a[40:43], v[200:203], a[112:115], a[40:43]
v_mfma_f32_16x16x32_bf16 a[72:75], v[200:203], a[116:119], a[72:75]
v_mfma_f32_16x16x32_bf16 a[12:15], v[204:207], a[108:111], a[12:15]
v_mfma_f32_16x16x32_bf16 a[44:47], v[204:207], a[112:115], a[44:47]
v_mfma_f32_16x16x32_bf16 a[76:79], v[204:207], a[116:119], a[76:79]
v_mfma_f32_16x16x32_bf16 a[16:19], v[208:211], a[108:111], a[16:19]
v_mfma_f32_16x16x32_bf16 a[48:51], v[208:211], a[112:115], a[48:51]
v_mfma_f32_16x16x32_bf16 a[80:83], v[208:211], a[116:119], a[80:83]
v_mfma_f32_16x16x32_bf16 a[20:23], v[212:215], a[108:111], a[20:23]
v_mfma_f32_16x16x32_bf16 a[52:55], v[212:215], a[112:115], a[52:55]
v_mfma_f32_16x16x32_bf16 a[84:87], v[212:215], a[116:119], a[84:87]
v_mfma_f32_16x16x32_bf16 a[24:27], v[216:219], a[108:111], a[24:27]
v_mfma_f32_16x16x32_bf16 a[56:59], v[216:219], a[112:115], a[56:59]
v_mfma_f32_16x16x32_bf16 a[88:91], v[216:219], a[116:119], a[88:91]
v_mfma_f32_16x16x32_bf16 a[28:31], v[220:223], a[108:111], a[28:31]
v_mfma_f32_16x16x32_bf16 a[60:63], v[220:223], a[112:115], a[60:63]
v_mfma_f32_16x16x32_bf16 a[92:95], v[220:223], a[116:119], a[92:95]
s_add_u32 s92, s75, 6
s_and_b32 s92, s92, 7
s_add_u32 s92, s92, 0
s_lshl_b32 s93, s92, 10
s_add_u32 s80, s72, s93
buffer_load_dwordx4 a[108:111], v5, s[44:47], s80 offen
buffer_load_dwordx4 a[112:115], v6, s[44:47], s80 offen
buffer_load_dwordx4 a[116:119], v7, s[44:47], s80 offen
s_mul_i32 s93, s92, 40960
s_add_u32 s81, s73, s93
buffer_load_dwordx4 v[64:67], v11, s[48:51], s81 offen
buffer_load_dwordx4 v[68:71], v11, s[48:51], s81 offen offset:1280
buffer_load_dwordx4 v[72:75], v11, s[48:51], s81 offen offset:2560
buffer_load_dwordx4 v[76:79], v11, s[48:51], s81 offen offset:3840
buffer_load_dwordx4 v[80:83], v12, s[48:51], s81 offen
buffer_load_dwordx4 v[84:87], v12, s[48:51], s81 offen offset:1280
buffer_load_dwordx4 v[88:91], v12, s[48:51], s81 offen offset:2560
buffer_load_dwordx4 v[92:95], v12, s[48:51], s81 offen offset:3840
s_waitcnt vmcnt(44)
v_perm_b32 v192, v100, v96, s11
v_perm_b32 v193, v108, v104, s11
v_perm_b32 v194, v116, v112, s11
v_perm_b32 v195, v124, v120, s11
v_perm_b32 v196, v100, v96, s12
v_perm_b32 v197, v108, v104, s12
v_perm_b32 v198, v116, v112, s12
v_perm_b32 v199, v124, v120, s12
v_perm_b32 v200, v101, v97, s11
v_perm_b32 v201, v109, v105, s11
v_perm_b32 v202, v117, v113, s11
v_perm_b32 v203, v125, v121, s11
v_perm_b32 v204, v101, v97, s12
v_perm_b32 v205, v109, v105, s12
v_perm_b32 v206, v117, v113, s12
v_perm_b32 v207, v125, v121, s12
v_perm_b32 v208, v102, v98, s11
v_perm_b32 v209, v110, v106, s11
v_perm_b32 v210, v118, v114, s11
v_perm_b32 v211, v126, v122, s11
v_perm_b32 v212, v102, v98, s12
v_perm_b32 v213, v110, v106, s12
v_perm_b32 v214, v118, v114, s12
v_perm_b32 v215, v126, v122, s12
v_perm_b32 v216, v103, v99, s11
v_perm_b32 v217, v111, v107, s11
v_perm_b32 v218, v119, v115, s11
v_perm_b32 v219, v127, v123, s11
v_perm_b32 v220, v103, v99, s12
v_perm_b32 v221, v111, v107, s12
v_perm_b32 v222, v119, v115, s12
v_perm_b32 v223, v127, v123, s12
v_mfma_f32_16x16x32_bf16 a[0:3], v[192:195], a[120:123], a[0:3]
v_mfma_f32_16x16x32_bf16 a[32:35], v[192:195], a[124:127], a[32:35]
v_mfma_f32_16x16x32_bf16 a[64:67], v[192:195], a[128:131], a[64:67]
v_mfma_f32_16x16x32_bf16 a[4:7], v[196:199], a[120:123], a[4:7]
v_mfma_f32_16x16x32_bf16 a[36:39], v[196:199], a[124:127], a[36:39]
v_mfma_f32_16x16x32_bf16 a[68:71], v[196:199], a[128:131], a[68:71]
v_mfma_f32_16x16x32_bf16 a[8:11], v[200:203], a[120:123], a[8:11]
v_mfma_f32_16x16x32_bf16 a[40:43], v[200:203], a[124:127], a[40:43]
v_mfma_f32_16x16x32_bf16 a[72:75], v[200:203], a[128:131], a[72:75]
v_mfma_f32_16x16x32_bf16 a[12:15], v[204:207], a[120:123], a[12:15]
v_mfma_f32_16x16x32_bf16 a[44:47], v[204:207], a[124:127], a[44:47]
v_mfma_f32_16x16x32_bf16 a[76:79], v[204:207], a[128:131], a[76:79]
v_mfma_f32_16x16x32_bf16 a[16:19], v[208:211], a[120:123], a[16:19]
v_mfma_f32_16x16x32_bf16 a[48:51], v[208:211], a[124:127], a[48:51]
v_mfma_f32_16x16x32_bf16 a[80:83], v[208:211], a[128:131], a[80:83]
v_mfma_f32_16x16x32_bf16 a[20:23], v[212:215], a[120:123], a[20:23]
v_mfma_f32_16x16x32_bf16 a[52:55], v[212:215], a[124:127], a[52:55]
v_mfma_f32_16x16x32_bf16 a[84:87], v[212:215], a[128:131], a[84:87]
v_mfma_f32_16x16x32_bf16 a[24:27], v[216:219], a[120:123], a[24:27]
v_mfma_f32_16x16x32_bf16 a[56:59], v[216:219], a[124:127], a[56:59]
v_mfma_f32_16x16x32_bf16 a[88:91], v[216:219], a[128:131], a[88:91]
v_mfma_f32_16x16x32_bf16 a[28:31], v[220:223], a[120:123], a[28:31]
v_mfma_f32_16x16x32_bf16 a[60:63], v[220:223], a[124:127], a[60:63]
v_mfma_f32_16x16x32_bf16 a[92:95], v[220:223], a[128:131], a[92:95]
s_add_u32 s92, s75, 7
s_and_b32 s92, s92, 7
s_add_u32 s92, s92, 0
s_lshl_b32 s93, s92, 10
s_add_u32 s82, s72, s93
buffer_load_dwordx4 a[120:123], v5, s[44:47], s82 offen
buffer_load_dwordx4 a[124:127], v6, s[44:47], s82 offen
buffer_load_dwordx4 a[128:131], v7, s[44:47], s82 offen
s_mul_i32 s93, s92, 40960
s_add_u32 s83, s73, s93
buffer_load_dwordx4 v[96:99], v11, s[48:51], s83 offen
buffer_load_dwordx4 v[100:103], v11, s[48:51], s83 offen offset:1280
buffer_load_dwordx4 v[104:107], v11, s[48:51], s83 offen offset:2560
buffer_load_dwordx4 v[108:111], v11, s[48:51], s83 offen offset:3840
buffer_load_dwordx4 v[112:115], v12, s[48:51], s83 offen
buffer_load_dwordx4 v[116:119], v12, s[48:51], s83 offen offset:1280
buffer_load_dwordx4 v[120:123], v12, s[48:51], s83 offen offset:2560
buffer_load_dwordx4 v[124:127], v12, s[48:51], s83 offen offset:3840
s_waitcnt vmcnt(44)
v_perm_b32 v192, v132, v128, s11
v_perm_b32 v193, v140, v136, s11
v_perm_b32 v194, v148, v144, s11
v_perm_b32 v195, v156, v152, s11
v_perm_b32 v196, v132, v128, s12
v_perm_b32 v197, v140, v136, s12
v_perm_b32 v198, v148, v144, s12
v_perm_b32 v199, v156, v152, s12
v_perm_b32 v200, v133, v129, s11
v_perm_b32 v201, v141, v137, s11
v_perm_b32 v202, v149, v145, s11
v_perm_b32 v203, v157, v153, s11
v_perm_b32 v204, v133, v129, s12
v_perm_b32 v205, v141, v137, s12
v_perm_b32 v206, v149, v145, s12
v_perm_b32 v207, v157, v153, s12
v_perm_b32 v208, v134, v130, s11
v_perm_b32 v209, v142, v138, s11
v_perm_b32 v210, v150, v146, s11
v_perm_b32 v211, v158, v154, s11
v_perm_b32 v212, v134, v130, s12
v_perm_b32 v213, v142, v138, s12
v_perm_b32 v214, v150, v146, s12
v_perm_b32 v215, v158, v154, s12
v_perm_b32 v216, v135, v131, s11
v_perm_b32 v217, v143, v139, s11
v_perm_b32 v218, v151, v147, s11
v_perm_b32 v219, v159, v155, s11
v_perm_b32 v220, v135, v131, s12
v_perm_b32 v221, v143, v139, s12
v_perm_b32 v222, v151, v147, s12
v_perm_b32 v223, v159, v155, s12
v_mfma_f32_16x16x32_bf16 a[0:3], v[192:195], a[132:135], a[0:3]
v_mfma_f32_16x16x32_bf16 a[32:35], v[192:195], a[136:139], a[32:35]
v_mfma_f32_16x16x32_bf16 a[64:67], v[192:195], a[140:143], a[64:67]
v_mfma_f32_16x16x32_bf16 a[4:7], v[196:199], a[132:135], a[4:7]
v_mfma_f32_16x16x32_bf16 a[36:39], v[196:199], a[136:139], a[36:39]
v_mfma_f32_16x16x32_bf16 a[68:71], v[196:199], a[140:143], a[68:71]
v_mfma_f32_16x16x32_bf16 a[8:11], v[200:203], a[132:135], a[8:11]
v_mfma_f32_16x16x32_bf16 a[40:43], v[200:203], a[136:139], a[40:43]
v_mfma_f32_16x16x32_bf16 a[72:75], v[200:203], a[140:143], a[72:75]
v_mfma_f32_16x16x32_bf16 a[12:15], v[204:207], a[132:135], a[12:15]
v_mfma_f32_16x16x32_bf16 a[44:47], v[204:207], a[136:139], a[44:47]
v_mfma_f32_16x16x32_bf16 a[76:79], v[204:207], a[140:143], a[76:79]
v_mfma_f32_16x16x32_bf16 a[16:19], v[208:211], a[132:135], a[16:19]
v_mfma_f32_16x16x32_bf16 a[48:51], v[208:211], a[136:139], a[48:51]
v_mfma_f32_16x16x32_bf16 a[80:83], v[208:211], a[140:143], a[80:83]
v_mfma_f32_16x16x32_bf16 a[20:23], v[212:215], a[132:135], a[20:23]
v_mfma_f32_16x16x32_bf16 a[52:55], v[212:215], a[136:139], a[52:55]
v_mfma_f32_16x16x32_bf16 a[84:87], v[212:215], a[140:143], a[84:87]
v_mfma_f32_16x16x32_bf16 a[24:27], v[216:219], a[132:135], a[24:27]
v_mfma_f32_16x16x32_bf16 a[56:59], v[216:219], a[136:139], a[56:59]
v_mfma_f32_16x16x32_bf16 a[88:91], v[216:219], a[140:143], a[88:91]
v_mfma_f32_16x16x32_bf16 a[28:31], v[220:223], a[132:135], a[28:31]
v_mfma_f32_16x16x32_bf16 a[60:63], v[220:223], a[136:139], a[60:63]
v_mfma_f32_16x16x32_bf16 a[92:95], v[220:223], a[140:143], a[92:95]
s_add_u32 s92, s75, 8
s_and_b32 s92, s92, 7
s_add_u32 s92, s92, 8
s_lshl_b32 s93, s92, 10
s_add_u32 s76, s72, s93
buffer_load_dwordx4 a[132:135], v5, s[44:47], s76 offen
buffer_load_dwordx4 a[136:139], v6, s[44:47], s76 offen
buffer_load_dwordx4 a[140:143], v7, s[44:47], s76 offen
s_mul_i32 s93, s92, 40960
s_add_u32 s77, s73, s93
buffer_load_dwordx4 v[128:131], v11, s[48:51], s77 offen
buffer_load_dwordx4 v[132:135], v11, s[48:51], s77 offen offset:1280
buffer_load_dwordx4 v[136:139], v11, s[48:51], s77 offen offset:2560
buffer_load_dwordx4 v[140:143], v11, s[48:51], s77 offen offset:3840
buffer_load_dwordx4 v[144:147], v12, s[48:51], s77 offen
buffer_load_dwordx4 v[148:151], v12, s[48:51], s77 offen offset:1280
buffer_load_dwordx4 v[152:155], v12, s[48:51], s77 offen offset:2560
buffer_load_dwordx4 v[156:159], v12, s[48:51], s77 offen offset:3840
s_waitcnt vmcnt(44)
v_perm_b32 v192, v164, v160, s11
v_perm_b32 v193, v172, v168, s11
v_perm_b32 v194, v180, v176, s11
v_perm_b32 v195, v188, v184, s11
v_perm_b32 v196, v164, v160, s12
v_perm_b32 v197, v172, v168, s12
v_perm_b32 v198, v180, v176, s12
v_perm_b32 v199, v188, v184, s12
v_perm_b32 v200, v165, v161, s11
v_perm_b32 v201, v173, v169, s11
v_perm_b32 v202, v181, v177, s11
v_perm_b32 v203, v189, v185, s11
v_perm_b32 v204, v165, v161, s12
v_perm_b32 v205, v173, v169, s12
v_perm_b32 v206, v181, v177, s12
v_perm_b32 v207, v189, v185, s12
v_perm_b32 v208, v166, v162, s11
v_perm_b32 v209, v174, v170, s11
v_perm_b32 v210, v182, v178, s11
v_perm_b32 v211, v190, v186, s11
v_perm_b32 v212, v166, v162, s12
v_perm_b32 v213, v174, v170, s12
v_perm_b32 v214, v182, v178, s12
v_perm_b32 v215, v190, v186, s12
v_perm_b32 v216, v167, v163, s11
v_perm_b32 v217, v175, v171, s11
v_perm_b32 v218, v183, v179, s11
v_perm_b32 v219, v191, v187, s11
v_perm_b32 v220, v167, v163, s12
v_perm_b32 v221, v175, v171, s12
v_perm_b32 v222, v183, v179, s12
v_perm_b32 v223, v191, v187, s12
v_mfma_f32_16x16x32_bf16 a[0:3], v[192:195], a[144:147], a[0:3]
v_mfma_f32_16x16x32_bf16 a[32:35], v[192:195], a[148:151], a[32:35]
v_mfma_f32_16x16x32_bf16 a[64:67], v[192:195], a[152:155], a[64:67]
v_mfma_f32_16x16x32_bf16 a[4:7], v[196:199], a[144:147], a[4:7]
v_mfma_f32_16x16x32_bf16 a[36:39], v[196:199], a[148:151], a[36:39]
v_mfma_f32_16x16x32_bf16 a[68:71], v[196:199], a[152:155], a[68:71]
v_mfma_f32_16x16x32_bf16 a[8:11], v[200:203], a[144:147], a[8:11]
v_mfma_f32_16x16x32_bf16 a[40:43], v[200:203], a[148:151], a[40:43]
v_mfma_f32_16x16x32_bf16 a[72:75], v[200:203], a[152:155], a[72:75]
v_mfma_f32_16x16x32_bf16 a[12:15], v[204:207], a[144:147], a[12:15]
v_mfma_f32_16x16x32_bf16 a[44:47], v[204:207], a[148:151], a[44:47]
v_mfma_f32_16x16x32_bf16 a[76:79], v[204:207], a[152:155], a[76:79]
v_mfma_f32_16x16x32_bf16 a[16:19], v[208:211], a[144:147], a[16:19]
v_mfma_f32_16x16x32_bf16 a[48:51], v[208:211], a[148:151], a[48:51]
v_mfma_f32_16x16x32_bf16 a[80:83], v[208:211], a[152:155], a[80:83]
v_mfma_f32_16x16x32_bf16 a[20:23], v[212:215], a[144:147], a[20:23]
v_mfma_f32_16x16x32_bf16 a[52:55], v[212:215], a[148:151], a[52:55]
v_mfma_f32_16x16x32_bf16 a[84:87], v[212:215], a[152:155], a[84:87]
v_mfma_f32_16x16x32_bf16 a[24:27], v[216:219], a[144:147], a[24:27]
v_mfma_f32_16x16x32_bf16 a[56:59], v[216:219], a[148:151], a[56:59]
v_mfma_f32_16x16x32_bf16 a[88:91], v[216:219], a[152:155], a[88:91]
v_mfma_f32_16x16x32_bf16 a[28:31], v[220:223], a[144:147], a[28:31]
v_mfma_f32_16x16x32_bf16 a[60:63], v[220:223], a[148:151], a[60:63]
v_mfma_f32_16x16x32_bf16 a[92:95], v[220:223], a[152:155], a[92:95]
s_add_u32 s92, s75, 9
s_and_b32 s92, s92, 7
s_add_u32 s92, s92, 8
s_lshl_b32 s93, s92, 10
s_add_u32 s78, s72, s93
buffer_load_dwordx4 a[144:147], v5, s[44:47], s78 offen
buffer_load_dwordx4 a[148:151], v6, s[44:47], s78 offen
buffer_load_dwordx4 a[152:155], v7, s[44:47], s78 offen
s_mul_i32 s93, s92, 40960
s_add_u32 s79, s73, s93
buffer_load_dwordx4 v[160:163], v11, s[48:51], s79 offen
buffer_load_dwordx4 v[164:167], v11, s[48:51], s79 offen offset:1280
buffer_load_dwordx4 v[168:171], v11, s[48:51], s79 offen offset:2560
buffer_load_dwordx4 v[172:175], v11, s[48:51], s79 offen offset:3840
buffer_load_dwordx4 v[176:179], v12, s[48:51], s79 offen
buffer_load_dwordx4 v[180:183], v12, s[48:51], s79 offen offset:1280
buffer_load_dwordx4 v[184:187], v12, s[48:51], s79 offen offset:2560
buffer_load_dwordx4 v[188:191], v12, s[48:51], s79 offen offset:3840
s_waitcnt vmcnt(44)
v_perm_b32 v192, v36, v32, s11
v_perm_b32 v193, v44, v40, s11
v_perm_b32 v194, v52, v48, s11
v_perm_b32 v195, v60, v56, s11
v_perm_b32 v196, v36, v32, s12
v_perm_b32 v197, v44, v40, s12
v_perm_b32 v198, v52, v48, s12
v_perm_b32 v199, v60, v56, s12
v_perm_b32 v200, v37, v33, s11
v_perm_b32 v201, v45, v41, s11
v_perm_b32 v202, v53, v49, s11
v_perm_b32 v203, v61, v57, s11
v_perm_b32 v204, v37, v33, s12
v_perm_b32 v205, v45, v41, s12
v_perm_b32 v206, v53, v49, s12
v_perm_b32 v207, v61, v57, s12
v_perm_b32 v208, v38, v34, s11
v_perm_b32 v209, v46, v42, s11
v_perm_b32 v210, v54, v50, s11
v_perm_b32 v211, v62, v58, s11
v_perm_b32 v212, v38, v34, s12
v_perm_b32 v213, v46, v42, s12
v_perm_b32 v214, v54, v50, s12
v_perm_b32 v215, v62, v58, s12
v_perm_b32 v216, v39, v35, s11
v_perm_b32 v217, v47, v43, s11
v_perm_b32 v218, v55, v51, s11
v_perm_b32 v219, v63, v59, s11
v_perm_b32 v220, v39, v35, s12
v_perm_b32 v221, v47, v43, s12
v_perm_b32 v222, v55, v51, s12
v_perm_b32 v223, v63, v59, s12
v_mfma_f32_16x16x32_bf16 a[0:3], v[192:195], a[96:99], a[0:3]
v_mfma_f32_16x16x32_bf16 a[32:35], v[192:195], a[100:103], a[32:35]
v_mfma_f32_16x16x32_bf16 a[64:67], v[192:195], a[104:107], a[64:67]
v_mfma_f32_16x16x32_bf16 a[4:7], v[196:199], a[96:99], a[4:7]
v_mfma_f32_16x16x32_bf16 a[36:39], v[196:199], a[100:103], a[36:39]
v_mfma_f32_16x16x32_bf16 a[68:71], v[196:199], a[104:107], a[68:71]
v_mfma_f32_16x16x32_bf16 a[8:11], v[200:203], a[96:99], a[8:11]
v_mfma_f32_16x16x32_bf16 a[40:43], v[200:203], a[100:103], a[40:43]
v_mfma_f32_16x16x32_bf16 a[72:75], v[200:203], a[104:107], a[72:75]
v_mfma_f32_16x16x32_bf16 a[12:15], v[204:207], a[96:99], a[12:15]
v_mfma_f32_16x16x32_bf16 a[44:47], v[204:207], a[100:103], a[44:47]
v_mfma_f32_16x16x32_bf16 a[76:79], v[204:207], a[104:107], a[76:79]
v_mfma_f32_16x16x32_bf16 a[16:19], v[208:211], a[96:99], a[16:19]
v_mfma_f32_16x16x32_bf16 a[48:51], v[208:211], a[100:103], a[48:51]
v_mfma_f32_16x16x32_bf16 a[80:83], v[208:211], a[104:107], a[80:83]
v_mfma_f32_16x16x32_bf16 a[20:23], v[212:215], a[96:99], a[20:23]
v_mfma_f32_16x16x32_bf16 a[52:55], v[212:215], a[100:103], a[52:55]
v_mfma_f32_16x16x32_bf16 a[84:87], v[212:215], a[104:107], a[84:87]
v_mfma_f32_16x16x32_bf16 a[24:27], v[216:219], a[96:99], a[24:27]
v_mfma_f32_16x16x32_bf16 a[56:59], v[216:219], a[100:103], a[56:59]
v_mfma_f32_16x16x32_bf16 a[88:91], v[216:219], a[104:107], a[88:91]
v_mfma_f32_16x16x32_bf16 a[28:31], v[220:223], a[96:99], a[28:31]
v_mfma_f32_16x16x32_bf16 a[60:63], v[220:223], a[100:103], a[60:63]
v_mfma_f32_16x16x32_bf16 a[92:95], v[220:223], a[104:107], a[92:95]
s_add_u32 s92, s75, 10
s_and_b32 s92, s92, 7
s_add_u32 s92, s92, 8
s_lshl_b32 s93, s92, 10
s_add_u32 s80, s72, s93
buffer_load_dwordx4 a[96:99], v5, s[44:47], s80 offen
buffer_load_dwordx4 a[100:103], v6, s[44:47], s80 offen
buffer_load_dwordx4 a[104:107], v7, s[44:47], s80 offen
s_mul_i32 s93, s92, 40960
s_add_u32 s81, s73, s93
buffer_load_dwordx4 v[32:35], v11, s[48:51], s81 offen
buffer_load_dwordx4 v[36:39], v11, s[48:51], s81 offen offset:1280
buffer_load_dwordx4 v[40:43], v11, s[48:51], s81 offen offset:2560
buffer_load_dwordx4 v[44:47], v11, s[48:51], s81 offen offset:3840
buffer_load_dwordx4 v[48:51], v12, s[48:51], s81 offen
buffer_load_dwordx4 v[52:55], v12, s[48:51], s81 offen offset:1280
buffer_load_dwordx4 v[56:59], v12, s[48:51], s81 offen offset:2560
buffer_load_dwordx4 v[60:63], v12, s[48:51], s81 offen offset:3840
s_waitcnt vmcnt(44)
v_perm_b32 v192, v68, v64, s11
v_perm_b32 v193, v76, v72, s11
v_perm_b32 v194, v84, v80, s11
v_perm_b32 v195, v92, v88, s11
v_perm_b32 v196, v68, v64, s12
v_perm_b32 v197, v76, v72, s12
v_perm_b32 v198, v84, v80, s12
v_perm_b32 v199, v92, v88, s12
v_perm_b32 v200, v69, v65, s11
v_perm_b32 v201, v77, v73, s11
v_perm_b32 v202, v85, v81, s11
v_perm_b32 v203, v93, v89, s11
v_perm_b32 v204, v69, v65, s12
v_perm_b32 v205, v77, v73, s12
v_perm_b32 v206, v85, v81, s12
v_perm_b32 v207, v93, v89, s12
v_perm_b32 v208, v70, v66, s11
v_perm_b32 v209, v78, v74, s11
v_perm_b32 v210, v86, v82, s11
v_perm_b32 v211, v94, v90, s11
v_perm_b32 v212, v70, v66, s12
v_perm_b32 v213, v78, v74, s12
v_perm_b32 v214, v86, v82, s12
v_perm_b32 v215, v94, v90, s12
v_perm_b32 v216, v71, v67, s11
v_perm_b32 v217, v79, v75, s11
v_perm_b32 v218, v87, v83, s11
v_perm_b32 v219, v95, v91, s11
v_perm_b32 v220, v71, v67, s12
v_perm_b32 v221, v79, v75, s12
v_perm_b32 v222, v87, v83, s12
v_perm_b32 v223, v95, v91, s12
v_mfma_f32_16x16x32_bf16 a[0:3], v[192:195], a[108:111], a[0:3]
v_mfma_f32_16x16x32_bf16 a[32:35], v[192:195], a[112:115], a[32:35]
v_mfma_f32_16x16x32_bf16 a[64:67], v[192:195], a[116:119], a[64:67]
v_mfma_f32_16x16x32_bf16 a[4:7], v[196:199], a[108:111], a[4:7]
v_mfma_f32_16x16x32_bf16 a[36:39], v[196:199], a[112:115], a[36:39]
v_mfma_f32_16x16x32_bf16 a[68:71], v[196:199], a[116:119], a[68:71]
v_mfma_f32_16x16x32_bf16 a[8:11], v[200:203], a[108:111], a[8:11]
v_mfma_f32_16x16x32_bf16 a[40:43], v[200:203], a[112:115], a[40:43]
v_mfma_f32_16x16x32_bf16 a[72:75], v[200:203], a[116:119], a[72:75]
v_mfma_f32_16x16x32_bf16 a[12:15], v[204:207], a[108:111], a[12:15]
v_mfma_f32_16x16x32_bf16 a[44:47], v[204:207], a[112:115], a[44:47]
v_mfma_f32_16x16x32_bf16 a[76:79], v[204:207], a[116:119], a[76:79]
v_mfma_f32_16x16x32_bf16 a[16:19], v[208:211], a[108:111], a[16:19]
v_mfma_f32_16x16x32_bf16 a[48:51], v[208:211], a[112:115], a[48:51]
v_mfma_f32_16x16x32_bf16 a[80:83], v[208:211], a[116:119], a[80:83]
v_mfma_f32_16x16x32_bf16 a[20:23], v[212:215], a[108:111], a[20:23]
v_mfma_f32_16x16x32_bf16 a[52:55], v[212:215], a[112:115], a[52:55]
v_mfma_f32_16x16x32_bf16 a[84:87], v[212:215], a[116:119], a[84:87]
v_mfma_f32_16x16x32_bf16 a[24:27], v[216:219], a[108:111], a[24:27]
v_mfma_f32_16x16x32_bf16 a[56:59], v[216:219], a[112:115], a[56:59]
v_mfma_f32_16x16x32_bf16 a[88:91], v[216:219], a[116:119], a[88:91]
v_mfma_f32_16x16x32_bf16 a[28:31], v[220:223], a[108:111], a[28:31]
v_mfma_f32_16x16x32_bf16 a[60:63], v[220:223], a[112:115], a[60:63]
v_mfma_f32_16x16x32_bf16 a[92:95], v[220:223], a[116:119], a[92:95]
s_add_u32 s92, s75, 11
s_and_b32 s92, s92, 7
s_add_u32 s92, s92, 8
s_lshl_b32 s93, s92, 10
s_add_u32 s82, s72, s93
buffer_load_dwordx4 a[108:111], v5, s[44:47], s82 offen
buffer_load_dwordx4 a[112:115], v6, s[44:47], s82 offen
buffer_load_dwordx4 a[116:119], v7, s[44:47], s82 offen
s_mul_i32 s93, s92, 40960
s_add_u32 s83, s73, s93
buffer_load_dwordx4 v[64:67], v11, s[48:51], s83 offen
buffer_load_dwordx4 v[68:71], v11, s[48:51], s83 offen offset:1280
buffer_load_dwordx4 v[72:75], v11, s[48:51], s83 offen offset:2560
buffer_load_dwordx4 v[76:79], v11, s[48:51], s83 offen offset:3840
buffer_load_dwordx4 v[80:83], v12, s[48:51], s83 offen
buffer_load_dwordx4 v[84:87], v12, s[48:51], s83 offen offset:1280
buffer_load_dwordx4 v[88:91], v12, s[48:51], s83 offen offset:2560
buffer_load_dwordx4 v[92:95], v12, s[48:51], s83 offen offset:3840
s_waitcnt vmcnt(44)
v_perm_b32 v192, v100, v96, s11
v_perm_b32 v193, v108, v104, s11
v_perm_b32 v194, v116, v112, s11
v_perm_b32 v195, v124, v120, s11
v_perm_b32 v196, v100, v96, s12
v_perm_b32 v197, v108, v104, s12
v_perm_b32 v198, v116, v112, s12
v_perm_b32 v199, v124, v120, s12
v_perm_b32 v200, v101, v97, s11
v_perm_b32 v201, v109, v105, s11
v_perm_b32 v202, v117, v113, s11
v_perm_b32 v203, v125, v121, s11
v_perm_b32 v204, v101, v97, s12
v_perm_b32 v205, v109, v105, s12
v_perm_b32 v206, v117, v113, s12
v_perm_b32 v207, v125, v121, s12
v_perm_b32 v208, v102, v98, s11
v_perm_b32 v209, v110, v106, s11
v_perm_b32 v210, v118, v114, s11
v_perm_b32 v211, v126, v122, s11
v_perm_b32 v212, v102, v98, s12
v_perm_b32 v213, v110, v106, s12
v_perm_b32 v214, v118, v114, s12
v_perm_b32 v215, v126, v122, s12
v_perm_b32 v216, v103, v99, s11
v_perm_b32 v217, v111, v107, s11
v_perm_b32 v218, v119, v115, s11
v_perm_b32 v219, v127, v123, s11
v_perm_b32 v220, v103, v99, s12
v_perm_b32 v221, v111, v107, s12
v_perm_b32 v222, v119, v115, s12
v_perm_b32 v223, v127, v123, s12
v_mfma_f32_16x16x32_bf16 a[0:3], v[192:195], a[120:123], a[0:3]
v_mfma_f32_16x16x32_bf16 a[32:35], v[192:195], a[124:127], a[32:35]
v_mfma_f32_16x16x32_bf16 a[64:67], v[192:195], a[128:131], a[64:67]
v_mfma_f32_16x16x32_bf16 a[4:7], v[196:199], a[120:123], a[4:7]
v_mfma_f32_16x16x32_bf16 a[36:39], v[196:199], a[124:127], a[36:39]
v_mfma_f32_16x16x32_bf16 a[68:71], v[196:199], a[128:131], a[68:71]
v_mfma_f32_16x16x32_bf16 a[8:11], v[200:203], a[120:123], a[8:11]
v_mfma_f32_16x16x32_bf16 a[40:43], v[200:203], a[124:127], a[40:43]
v_mfma_f32_16x16x32_bf16 a[72:75], v[200:203], a[128:131], a[72:75]
v_mfma_f32_16x16x32_bf16 a[12:15], v[204:207], a[120:123], a[12:15]
v_mfma_f32_16x16x32_bf16 a[44:47], v[204:207], a[124:127], a[44:47]
v_mfma_f32_16x16x32_bf16 a[76:79], v[204:207], a[128:131], a[76:79]
v_mfma_f32_16x16x32_bf16 a[16:19], v[208:211], a[120:123], a[16:19]
v_mfma_f32_16x16x32_bf16 a[48:51], v[208:211], a[124:127], a[48:51]
v_mfma_f32_16x16x32_bf16 a[80:83], v[208:211], a[128:131], a[80:83]
v_mfma_f32_16x16x32_bf16 a[20:23], v[212:215], a[120:123], a[20:23]
v_mfma_f32_16x16x32_bf16 a[52:55], v[212:215], a[124:127], a[52:55]
v_mfma_f32_16x16x32_bf16 a[84:87], v[212:215], a[128:131], a[84:87]
v_mfma_f32_16x16x32_bf16 a[24:27], v[216:219], a[120:123], a[24:27]
v_mfma_f32_16x16x32_bf16 a[56:59], v[216:219], a[124:127], a[56:59]
v_mfma_f32_16x16x32_bf16 a[88:91], v[216:219], a[128:131], a[88:91]
v_mfma_f32_16x16x32_bf16 a[28:31], v[220:223], a[120:123], a[28:31]
v_mfma_f32_16x16x32_bf16 a[60:63], v[220:223], a[124:127], a[60:63]
v_mfma_f32_16x16x32_bf16 a[92:95], v[220:223], a[128:131], a[92:95]
s_add_u32 s92, s75, 12
s_and_b32 s92, s92, 7
s_add_u32 s92, s92, 8
s_lshl_b32 s93, s92, 10
s_add_u32 s76, s72, s93
buffer_load_dwordx4 a[120:123], v5, s[44:47], s76 offen
buffer_load_dwordx4 a[124:127], v6, s[44:47], s76 offen
buffer_load_dwordx4 a[128:131], v7, s[44:47], s76 offen
s_mul_i32 s93, s92, 40960
s_add_u32 s77, s73, s93
buffer_load_dwordx4 v[96:99], v11, s[48:51], s77 offen
buffer_load_dwordx4 v[100:103], v11, s[48:51], s77 offen offset:1280
buffer_load_dwordx4 v[104:107], v11, s[48:51], s77 offen offset:2560
buffer_load_dwordx4 v[108:111], v11, s[48:51], s77 offen offset:3840
buffer_load_dwordx4 v[112:115], v12, s[48:51], s77 offen
buffer_load_dwordx4 v[116:119], v12, s[48:51], s77 offen offset:1280
buffer_load_dwordx4 v[120:123], v12, s[48:51], s77 offen offset:2560
buffer_load_dwordx4 v[124:127], v12, s[48:51], s77 offen offset:3840
s_waitcnt vmcnt(44)
v_perm_b32 v192, v132, v128, s11
v_perm_b32 v193, v140, v136, s11
v_perm_b32 v194, v148, v144, s11
v_perm_b32 v195, v156, v152, s11
v_perm_b32 v196, v132, v128, s12
v_perm_b32 v197, v140, v136, s12
v_perm_b32 v198, v148, v144, s12
v_perm_b32 v199, v156, v152, s12
v_perm_b32 v200, v133, v129, s11
v_perm_b32 v201, v141, v137, s11
v_perm_b32 v202, v149, v145, s11
v_perm_b32 v203, v157, v153, s11
v_perm_b32 v204, v133, v129, s12
v_perm_b32 v205, v141, v137, s12
v_perm_b32 v206, v149, v145, s12
v_perm_b32 v207, v157, v153, s12
v_perm_b32 v208, v134, v130, s11
v_perm_b32 v209, v142, v138, s11
v_perm_b32 v210, v150, v146, s11
v_perm_b32 v211, v158, v154, s11
v_perm_b32 v212, v134, v130, s12
v_perm_b32 v213, v142, v138, s12
v_perm_b32 v214, v150, v146, s12
v_perm_b32 v215, v158, v154, s12
v_perm_b32 v216, v135, v131, s11
v_perm_b32 v217, v143, v139, s11
v_perm_b32 v218, v151, v147, s11
v_perm_b32 v219, v159, v155, s11
v_perm_b32 v220, v135, v131, s12
v_perm_b32 v221, v143, v139, s12
v_perm_b32 v222, v151, v147, s12
v_perm_b32 v223, v159, v155, s12
v_mfma_f32_16x16x32_bf16 a[0:3], v[192:195], a[132:135], a[0:3]
v_mfma_f32_16x16x32_bf16 a[32:35], v[192:195], a[136:139], a[32:35]
v_mfma_f32_16x16x32_bf16 a[64:67], v[192:195], a[140:143], a[64:67]
v_mfma_f32_16x16x32_bf16 a[4:7], v[196:199], a[132:135], a[4:7]
v_mfma_f32_16x16x32_bf16 a[36:39], v[196:199], a[136:139], a[36:39]
v_mfma_f32_16x16x32_bf16 a[68:71], v[196:199], a[140:143], a[68:71]
v_mfma_f32_16x16x32_bf16 a[8:11], v[200:203], a[132:135], a[8:11]
v_mfma_f32_16x16x32_bf16 a[40:43], v[200:203], a[136:139], a[40:43]
v_mfma_f32_16x16x32_bf16 a[72:75], v[200:203], a[140:143], a[72:75]
v_mfma_f32_16x16x32_bf16 a[12:15], v[204:207], a[132:135], a[12:15]
v_mfma_f32_16x16x32_bf16 a[44:47], v[204:207], a[136:139], a[44:47]
v_mfma_f32_16x16x32_bf16 a[76:79], v[204:207], a[140:143], a[76:79]
v_mfma_f32_16x16x32_bf16 a[16:19], v[208:211], a[132:135], a[16:19]
v_mfma_f32_16x16x32_bf16 a[48:51], v[208:211], a[136:139], a[48:51]
v_mfma_f32_16x16x32_bf16 a[80:83], v[208:211], a[140:143], a[80:83]
v_mfma_f32_16x16x32_bf16 a[20:23], v[212:215], a[132:135], a[20:23]
v_mfma_f32_16x16x32_bf16 a[52:55], v[212:215], a[136:139], a[52:55]
v_mfma_f32_16x16x32_bf16 a[84:87], v[212:215], a[140:143], a[84:87]
v_mfma_f32_16x16x32_bf16 a[24:27], v[216:219], a[132:135], a[24:27]
v_mfma_f32_16x16x32_bf16 a[56:59], v[216:219], a[136:139], a[56:59]
v_mfma_f32_16x16x32_bf16 a[88:91], v[216:219], a[140:143], a[88:91]
v_mfma_f32_16x16x32_bf16 a[28:31], v[220:223], a[132:135], a[28:31]
v_mfma_f32_16x16x32_bf16 a[60:63], v[220:223], a[136:139], a[60:63]
v_mfma_f32_16x16x32_bf16 a[92:95], v[220:223], a[140:143], a[92:95]
s_add_u32 s92, s75, 13
s_and_b32 s92, s92, 7
s_add_u32 s92, s92, 8
s_lshl_b32 s93, s92, 10
s_add_u32 s78, s72, s93
buffer_load_dwordx4 a[132:135], v5, s[44:47], s78 offen
buffer_load_dwordx4 a[136:139], v6, s[44:47], s78 offen
buffer_load_dwordx4 a[140:143], v7, s[44:47], s78 offen
s_mul_i32 s93, s92, 40960
s_add_u32 s79, s73, s93
buffer_load_dwordx4 v[128:131], v11, s[48:51], s79 offen
buffer_load_dwordx4 v[132:135], v11, s[48:51], s79 offen offset:1280
buffer_load_dwordx4 v[136:139], v11, s[48:51], s79 offen offset:2560
buffer_load_dwordx4 v[140:143], v11, s[48:51], s79 offen offset:3840
buffer_load_dwordx4 v[144:147], v12, s[48:51], s79 offen
buffer_load_dwordx4 v[148:151], v12, s[48:51], s79 offen offset:1280
buffer_load_dwordx4 v[152:155], v12, s[48:51], s79 offen offset:2560
buffer_load_dwordx4 v[156:159], v12, s[48:51], s79 offen offset:3840
s_waitcnt vmcnt(44)
v_perm_b32 v192, v164, v160, s11
v_perm_b32 v193, v172, v168, s11
v_perm_b32 v194, v180, v176, s11
v_perm_b32 v195, v188, v184, s11
v_perm_b32 v196, v164, v160, s12
v_perm_b32 v197, v172, v168, s12
v_perm_b32 v198, v180, v176, s12
v_perm_b32 v199, v188, v184, s12
v_perm_b32 v200, v165, v161, s11
v_perm_b32 v201, v173, v169, s11
v_perm_b32 v202, v181, v177, s11
v_perm_b32 v203, v189, v185, s11
v_perm_b32 v204, v165, v161, s12
v_perm_b32 v205, v173, v169, s12
v_perm_b32 v206, v181, v177, s12
v_perm_b32 v207, v189, v185, s12
v_perm_b32 v208, v166, v162, s11
v_perm_b32 v209, v174, v170, s11
v_perm_b32 v210, v182, v178, s11
v_perm_b32 v211, v190, v186, s11
v_perm_b32 v212, v166, v162, s12
v_perm_b32 v213, v174, v170, s12
v_perm_b32 v214, v182, v178, s12
v_perm_b32 v215, v190, v186, s12
v_perm_b32 v216, v167, v163, s11
v_perm_b32 v217, v175, v171, s11
v_perm_b32 v218, v183, v179, s11
v_perm_b32 v219, v191, v187, s11
v_perm_b32 v220, v167, v163, s12
v_perm_b32 v221, v175, v171, s12
v_perm_b32 v222, v183, v179, s12
v_perm_b32 v223, v191, v187, s12
v_mfma_f32_16x16x32_bf16 a[0:3], v[192:195], a[144:147], a[0:3]
v_mfma_f32_16x16x32_bf16 a[32:35], v[192:195], a[148:151], a[32:35]
v_mfma_f32_16x16x32_bf16 a[64:67], v[192:195], a[152:155], a[64:67]
v_mfma_f32_16x16x32_bf16 a[4:7], v[196:199], a[144:147], a[4:7]
v_mfma_f32_16x16x32_bf16 a[36:39], v[196:199], a[148:151], a[36:39]
v_mfma_f32_16x16x32_bf16 a[68:71], v[196:199], a[152:155], a[68:71]
v_mfma_f32_16x16x32_bf16 a[8:11], v[200:203], a[144:147], a[8:11]
v_mfma_f32_16x16x32_bf16 a[40:43], v[200:203], a[148:151], a[40:43]
v_mfma_f32_16x16x32_bf16 a[72:75], v[200:203], a[152:155], a[72:75]
v_mfma_f32_16x16x32_bf16 a[12:15], v[204:207], a[144:147], a[12:15]
v_mfma_f32_16x16x32_bf16 a[44:47], v[204:207], a[148:151], a[44:47]
v_mfma_f32_16x16x32_bf16 a[76:79], v[204:207], a[152:155], a[76:79]
v_mfma_f32_16x16x32_bf16 a[16:19], v[208:211], a[144:147], a[16:19]
v_mfma_f32_16x16x32_bf16 a[48:51], v[208:211], a[148:151], a[48:51]
v_mfma_f32_16x16x32_bf16 a[80:83], v[208:211], a[152:155], a[80:83]
v_mfma_f32_16x16x32_bf16 a[20:23], v[212:215], a[144:147], a[20:23]
v_mfma_f32_16x16x32_bf16 a[52:55], v[212:215], a[148:151], a[52:55]
v_mfma_f32_16x16x32_bf16 a[84:87], v[212:215], a[152:155], a[84:87]
v_mfma_f32_16x16x32_bf16 a[24:27], v[216:219], a[144:147], a[24:27]
v_mfma_f32_16x16x32_bf16 a[56:59], v[216:219], a[148:151], a[56:59]
v_mfma_f32_16x16x32_bf16 a[88:91], v[216:219], a[152:155], a[88:91]
v_mfma_f32_16x16x32_bf16 a[28:31], v[220:223], a[144:147], a[28:31]
v_mfma_f32_16x16x32_bf16 a[60:63], v[220:223], a[148:151], a[60:63]
v_mfma_f32_16x16x32_bf16 a[92:95], v[220:223], a[152:155], a[92:95]
s_add_u32 s92, s75, 14
s_and_b32 s92, s92, 7
s_add_u32 s92, s92, 8
s_lshl_b32 s93, s92, 10
s_add_u32 s80, s72, s93
buffer_load_dwordx4 a[144:147], v5, s[44:47], s80 offen
buffer_load_dwordx4 a[148:151], v6, s[44:47], s80 offen
buffer_load_dwordx4 a[152:155], v7, s[44:47], s80 offen
s_mul_i32 s93, s92, 40960
s_add_u32 s81, s73, s93
buffer_load_dwordx4 v[160:163], v11, s[48:51], s81 offen
buffer_load_dwordx4 v[164:167], v11, s[48:51], s81 offen offset:1280
buffer_load_dwordx4 v[168:171], v11, s[48:51], s81 offen offset:2560
buffer_load_dwordx4 v[172:175], v11, s[48:51], s81 offen offset:3840
buffer_load_dwordx4 v[176:179], v12, s[48:51], s81 offen
buffer_load_dwordx4 v[180:183], v12, s[48:51], s81 offen offset:1280
buffer_load_dwordx4 v[184:187], v12, s[48:51], s81 offen offset:2560
buffer_load_dwordx4 v[188:191], v12, s[48:51], s81 offen offset:3840
s_waitcnt vmcnt(44)
v_perm_b32 v192, v36, v32, s11
v_perm_b32 v193, v44, v40, s11
v_perm_b32 v194, v52, v48, s11
v_perm_b32 v195, v60, v56, s11
v_perm_b32 v196, v36, v32, s12
v_perm_b32 v197, v44, v40, s12
v_perm_b32 v198, v52, v48, s12
v_perm_b32 v199, v60, v56, s12
v_perm_b32 v200, v37, v33, s11
v_perm_b32 v201, v45, v41, s11
v_perm_b32 v202, v53, v49, s11
v_perm_b32 v203, v61, v57, s11
v_perm_b32 v204, v37, v33, s12
v_perm_b32 v205, v45, v41, s12
v_perm_b32 v206, v53, v49, s12
v_perm_b32 v207, v61, v57, s12
v_perm_b32 v208, v38, v34, s11
v_perm_b32 v209, v46, v42, s11
v_perm_b32 v210, v54, v50, s11
v_perm_b32 v211, v62, v58, s11
v_perm_b32 v212, v38, v34, s12
v_perm_b32 v213, v46, v42, s12
v_perm_b32 v214, v54, v50, s12
v_perm_b32 v215, v62, v58, s12
v_perm_b32 v216, v39, v35, s11
v_perm_b32 v217, v47, v43, s11
v_perm_b32 v218, v55, v51, s11
v_perm_b32 v219, v63, v59, s11
v_perm_b32 v220, v39, v35, s12
v_perm_b32 v221, v47, v43, s12
v_perm_b32 v222, v55, v51, s12
v_perm_b32 v223, v63, v59, s12
v_mfma_f32_16x16x32_bf16 a[0:3], v[192:195], a[96:99], a[0:3]
v_mfma_f32_16x16x32_bf16 a[32:35], v[192:195], a[100:103], a[32:35]
v_mfma_f32_16x16x32_bf16 a[64:67], v[192:195], a[104:107], a[64:67]
v_mfma_f32_16x16x32_bf16 a[4:7], v[196:199], a[96:99], a[4:7]
v_mfma_f32_16x16x32_bf16 a[36:39], v[196:199], a[100:103], a[36:39]
v_mfma_f32_16x16x32_bf16 a[68:71], v[196:199], a[104:107], a[68:71]
v_mfma_f32_16x16x32_bf16 a[8:11], v[200:203], a[96:99], a[8:11]
v_mfma_f32_16x16x32_bf16 a[40:43], v[200:203], a[100:103], a[40:43]
v_mfma_f32_16x16x32_bf16 a[72:75], v[200:203], a[104:107], a[72:75]
v_mfma_f32_16x16x32_bf16 a[12:15], v[204:207], a[96:99], a[12:15]
v_mfma_f32_16x16x32_bf16 a[44:47], v[204:207], a[100:103], a[44:47]
v_mfma_f32_16x16x32_bf16 a[76:79], v[204:207], a[104:107], a[76:79]
v_mfma_f32_16x16x32_bf16 a[16:19], v[208:211], a[96:99], a[16:19]
v_mfma_f32_16x16x32_bf16 a[48:51], v[208:211], a[100:103], a[48:51]
v_mfma_f32_16x16x32_bf16 a[80:83], v[208:211], a[104:107], a[80:83]
v_mfma_f32_16x16x32_bf16 a[20:23], v[212:215], a[96:99], a[20:23]
v_mfma_f32_16x16x32_bf16 a[52:55], v[212:215], a[100:103], a[52:55]
v_mfma_f32_16x16x32_bf16 a[84:87], v[212:215], a[104:107], a[84:87]
v_mfma_f32_16x16x32_bf16 a[24:27], v[216:219], a[96:99], a[24:27]
v_mfma_f32_16x16x32_bf16 a[56:59], v[216:219], a[100:103], a[56:59]
v_mfma_f32_16x16x32_bf16 a[88:91], v[216:219], a[104:107], a[88:91]
v_mfma_f32_16x16x32_bf16 a[28:31], v[220:223], a[96:99], a[28:31]
v_mfma_f32_16x16x32_bf16 a[60:63], v[220:223], a[100:103], a[60:63]
v_mfma_f32_16x16x32_bf16 a[92:95], v[220:223], a[104:107], a[92:95]
s_add_u32 s92, s75, 15
s_and_b32 s92, s92, 7
s_add_u32 s92, s92, 8
s_lshl_b32 s93, s92, 10
s_add_u32 s82, s72, s93
buffer_load_dwordx4 a[96:99], v5, s[44:47], s82 offen
buffer_load_dwordx4 a[100:103], v6, s[44:47], s82 offen
buffer_load_dwordx4 a[104:107], v7, s[44:47], s82 offen
s_mul_i32 s93, s92, 40960
s_add_u32 s83, s73, s93
buffer_load_dwordx4 v[32:35], v11, s[48:51], s83 offen
buffer_load_dwordx4 v[36:39], v11, s[48:51], s83 offen offset:1280
buffer_load_dwordx4 v[40:43], v11, s[48:51], s83 offen offset:2560
buffer_load_dwordx4 v[44:47], v11, s[48:51], s83 offen offset:3840
buffer_load_dwordx4 v[48:51], v12, s[48:51], s83 offen
buffer_load_dwordx4 v[52:55], v12, s[48:51], s83 offen offset:1280
buffer_load_dwordx4 v[56:59], v12, s[48:51], s83 offen offset:2560
buffer_load_dwordx4 v[60:63], v12, s[48:51], s83 offen offset:3840
s_waitcnt vmcnt(44)
v_perm_b32 v192, v68, v64, s11
v_perm_b32 v193, v76, v72, s11
v_perm_b32 v194, v84, v80, s11
v_perm_b32 v195, v92, v88, s11
v_perm_b32 v196, v68, v64, s12
v_perm_b32 v197, v76, v72, s12
v_perm_b32 v198, v84, v80, s12
v_perm_b32 v199, v92, v88, s12
v_perm_b32 v200, v69, v65, s11
v_perm_b32 v201, v77, v73, s11
v_perm_b32 v202, v85, v81, s11
v_perm_b32 v203, v93, v89, s11
v_perm_b32 v204, v69, v65, s12
v_perm_b32 v205, v77, v73, s12
v_perm_b32 v206, v85, v81, s12
v_perm_b32 v207, v93, v89, s12
v_perm_b32 v208, v70, v66, s11
v_perm_b32 v209, v78, v74, s11
v_perm_b32 v210, v86, v82, s11
v_perm_b32 v211, v94, v90, s11
v_perm_b32 v212, v70, v66, s12
v_perm_b32 v213, v78, v74, s12
v_perm_b32 v214, v86, v82, s12
v_perm_b32 v215, v94, v90, s12
v_perm_b32 v216, v71, v67, s11
v_perm_b32 v217, v79, v75, s11
v_perm_b32 v218, v87, v83, s11
v_perm_b32 v219, v95, v91, s11
v_perm_b32 v220, v71, v67, s12
v_perm_b32 v221, v79, v75, s12
v_perm_b32 v222, v87, v83, s12
v_perm_b32 v223, v95, v91, s12
v_mfma_f32_16x16x32_bf16 a[0:3], v[192:195], a[108:111], a[0:3]
v_mfma_f32_16x16x32_bf16 a[32:35], v[192:195], a[112:115], a[32:35]
v_mfma_f32_16x16x32_bf16 a[64:67], v[192:195], a[116:119], a[64:67]
v_mfma_f32_16x16x32_bf16 a[4:7], v[196:199], a[108:111], a[4:7]
v_mfma_f32_16x16x32_bf16 a[36:39], v[196:199], a[112:115], a[36:39]
v_mfma_f32_16x16x32_bf16 a[68:71], v[196:199], a[116:119], a[68:71]
v_mfma_f32_16x16x32_bf16 a[8:11], v[200:203], a[108:111], a[8:11]
v_mfma_f32_16x16x32_bf16 a[40:43], v[200:203], a[112:115], a[40:43]
v_mfma_f32_16x16x32_bf16 a[72:75], v[200:203], a[116:119], a[72:75]
v_mfma_f32_16x16x32_bf16 a[12:15], v[204:207], a[108:111], a[12:15]
v_mfma_f32_16x16x32_bf16 a[44:47], v[204:207], a[112:115], a[44:47]
v_mfma_f32_16x16x32_bf16 a[76:79], v[204:207], a[116:119], a[76:79]
v_mfma_f32_16x16x32_bf16 a[16:19], v[208:211], a[108:111], a[16:19]
v_mfma_f32_16x16x32_bf16 a[48:51], v[208:211], a[112:115], a[48:51]
v_mfma_f32_16x16x32_bf16 a[80:83], v[208:211], a[116:119], a[80:83]
v_mfma_f32_16x16x32_bf16 a[20:23], v[212:215], a[108:111], a[20:23]
v_mfma_f32_16x16x32_bf16 a[52:55], v[212:215], a[112:115], a[52:55]
v_mfma_f32_16x16x32_bf16 a[84:87], v[212:215], a[116:119], a[84:87]
v_mfma_f32_16x16x32_bf16 a[24:27], v[216:219], a[108:111], a[24:27]
v_mfma_f32_16x16x32_bf16 a[56:59], v[216:219], a[112:115], a[56:59]
v_mfma_f32_16x16x32_bf16 a[88:91], v[216:219], a[116:119], a[88:91]
v_mfma_f32_16x16x32_bf16 a[28:31], v[220:223], a[108:111], a[28:31]
v_mfma_f32_16x16x32_bf16 a[60:63], v[220:223], a[112:115], a[60:63]
v_mfma_f32_16x16x32_bf16 a[92:95], v[220:223], a[116:119], a[92:95]
s_add_u32 s92, s75, 16
s_and_b32 s92, s92, 7
s_add_u32 s92, s92, 16
s_lshl_b32 s93, s92, 10
s_add_u32 s76, s72, s93
buffer_load_dwordx4 a[108:111], v5, s[44:47], s76 offen
buffer_load_dwordx4 a[112:115], v6, s[44:47], s76 offen
buffer_load_dwordx4 a[116:119], v7, s[44:47], s76 offen
s_mul_i32 s93, s92, 40960
s_add_u32 s77, s73, s93
buffer_load_dwordx4 v[64:67], v11, s[48:51], s77 offen
buffer_load_dwordx4 v[68:71], v11, s[48:51], s77 offen offset:1280
buffer_load_dwordx4 v[72:75], v11, s[48:51], s77 offen offset:2560
buffer_load_dwordx4 v[76:79], v11, s[48:51], s77 offen offset:3840
buffer_load_dwordx4 v[80:83], v12, s[48:51], s77 offen
buffer_load_dwordx4 v[84:87], v12, s[48:51], s77 offen offset:1280
buffer_load_dwordx4 v[88:91], v12, s[48:51], s77 offen offset:2560
buffer_load_dwordx4 v[92:95], v12, s[48:51], s77 offen offset:3840
s_waitcnt vmcnt(44)
v_perm_b32 v192, v100, v96, s11
v_perm_b32 v193, v108, v104, s11
v_perm_b32 v194, v116, v112, s11
v_perm_b32 v195, v124, v120, s11
v_perm_b32 v196, v100, v96, s12
v_perm_b32 v197, v108, v104, s12
v_perm_b32 v198, v116, v112, s12
v_perm_b32 v199, v124, v120, s12
v_perm_b32 v200, v101, v97, s11
v_perm_b32 v201, v109, v105, s11
v_perm_b32 v202, v117, v113, s11
v_perm_b32 v203, v125, v121, s11
v_perm_b32 v204, v101, v97, s12
v_perm_b32 v205, v109, v105, s12
v_perm_b32 v206, v117, v113, s12
v_perm_b32 v207, v125, v121, s12
v_perm_b32 v208, v102, v98, s11
v_perm_b32 v209, v110, v106, s11
v_perm_b32 v210, v118, v114, s11
v_perm_b32 v211, v126, v122, s11
v_perm_b32 v212, v102, v98, s12
v_perm_b32 v213, v110, v106, s12
v_perm_b32 v214, v118, v114, s12
v_perm_b32 v215, v126, v122, s12
v_perm_b32 v216, v103, v99, s11
v_perm_b32 v217, v111, v107, s11
v_perm_b32 v218, v119, v115, s11
v_perm_b32 v219, v127, v123, s11
v_perm_b32 v220, v103, v99, s12
v_perm_b32 v221, v111, v107, s12
v_perm_b32 v222, v119, v115, s12
v_perm_b32 v223, v127, v123, s12
v_mfma_f32_16x16x32_bf16 a[0:3], v[192:195], a[120:123], a[0:3]
v_mfma_f32_16x16x32_bf16 a[32:35], v[192:195], a[124:127], a[32:35]
v_mfma_f32_16x16x32_bf16 a[64:67], v[192:195], a[128:131], a[64:67]
v_mfma_f32_16x16x32_bf16 a[4:7], v[196:199], a[120:123], a[4:7]
v_mfma_f32_16x16x32_bf16 a[36:39], v[196:199], a[124:127], a[36:39]
v_mfma_f32_16x16x32_bf16 a[68:71], v[196:199], a[128:131], a[68:71]
v_mfma_f32_16x16x32_bf16 a[8:11], v[200:203], a[120:123], a[8:11]
v_mfma_f32_16x16x32_bf16 a[40:43], v[200:203], a[124:127], a[40:43]
v_mfma_f32_16x16x32_bf16 a[72:75], v[200:203], a[128:131], a[72:75]
v_mfma_f32_16x16x32_bf16 a[12:15], v[204:207], a[120:123], a[12:15]
v_mfma_f32_16x16x32_bf16 a[44:47], v[204:207], a[124:127], a[44:47]
v_mfma_f32_16x16x32_bf16 a[76:79], v[204:207], a[128:131], a[76:79]
v_mfma_f32_16x16x32_bf16 a[16:19], v[208:211], a[120:123], a[16:19]
v_mfma_f32_16x16x32_bf16 a[48:51], v[208:211], a[124:127], a[48:51]
v_mfma_f32_16x16x32_bf16 a[80:83], v[208:211], a[128:131], a[80:83]
v_mfma_f32_16x16x32_bf16 a[20:23], v[212:215], a[120:123], a[20:23]
v_mfma_f32_16x16x32_bf16 a[52:55], v[212:215], a[124:127], a[52:55]
v_mfma_f32_16x16x32_bf16 a[84:87], v[212:215], a[128:131], a[84:87]
v_mfma_f32_16x16x32_bf16 a[24:27], v[216:219], a[120:123], a[24:27]
v_mfma_f32_16x16x32_bf16 a[56:59], v[216:219], a[124:127], a[56:59]
v_mfma_f32_16x16x32_bf16 a[88:91], v[216:219], a[128:131], a[88:91]
v_mfma_f32_16x16x32_bf16 a[28:31], v[220:223], a[120:123], a[28:31]
v_mfma_f32_16x16x32_bf16 a[60:63], v[220:223], a[124:127], a[60:63]
v_mfma_f32_16x16x32_bf16 a[92:95], v[220:223], a[128:131], a[92:95]
s_add_u32 s92, s75, 17
s_and_b32 s92, s92, 7
s_add_u32 s92, s92, 16
s_lshl_b32 s93, s92, 10
s_add_u32 s78, s72, s93
buffer_load_dwordx4 a[120:123], v5, s[44:47], s78 offen
buffer_load_dwordx4 a[124:127], v6, s[44:47], s78 offen
buffer_load_dwordx4 a[128:131], v7, s[44:47], s78 offen
s_mul_i32 s93, s92, 40960
s_add_u32 s79, s73, s93
buffer_load_dwordx4 v[96:99], v11, s[48:51], s79 offen
buffer_load_dwordx4 v[100:103], v11, s[48:51], s79 offen offset:1280
buffer_load_dwordx4 v[104:107], v11, s[48:51], s79 offen offset:2560
buffer_load_dwordx4 v[108:111], v11, s[48:51], s79 offen offset:3840
buffer_load_dwordx4 v[112:115], v12, s[48:51], s79 offen
buffer_load_dwordx4 v[116:119], v12, s[48:51], s79 offen offset:1280
buffer_load_dwordx4 v[120:123], v12, s[48:51], s79 offen offset:2560
buffer_load_dwordx4 v[124:127], v12, s[48:51], s79 offen offset:3840
s_waitcnt vmcnt(44)
v_perm_b32 v192, v132, v128, s11
v_perm_b32 v193, v140, v136, s11
v_perm_b32 v194, v148, v144, s11
v_perm_b32 v195, v156, v152, s11
v_perm_b32 v196, v132, v128, s12
v_perm_b32 v197, v140, v136, s12
v_perm_b32 v198, v148, v144, s12
v_perm_b32 v199, v156, v152, s12
v_perm_b32 v200, v133, v129, s11
v_perm_b32 v201, v141, v137, s11
v_perm_b32 v202, v149, v145, s11
v_perm_b32 v203, v157, v153, s11
v_perm_b32 v204, v133, v129, s12
v_perm_b32 v205, v141, v137, s12
v_perm_b32 v206, v149, v145, s12
v_perm_b32 v207, v157, v153, s12
v_perm_b32 v208, v134, v130, s11
v_perm_b32 v209, v142, v138, s11
v_perm_b32 v210, v150, v146, s11
v_perm_b32 v211, v158, v154, s11
v_perm_b32 v212, v134, v130, s12
v_perm_b32 v213, v142, v138, s12
v_perm_b32 v214, v150, v146, s12
v_perm_b32 v215, v158, v154, s12
v_perm_b32 v216, v135, v131, s11
v_perm_b32 v217, v143, v139, s11
v_perm_b32 v218, v151, v147, s11
v_perm_b32 v219, v159, v155, s11
v_perm_b32 v220, v135, v131, s12
v_perm_b32 v221, v143, v139, s12
v_perm_b32 v222, v151, v147, s12
v_perm_b32 v223, v159, v155, s12
v_mfma_f32_16x16x32_bf16 a[0:3], v[192:195], a[132:135], a[0:3]
v_mfma_f32_16x16x32_bf16 a[32:35], v[192:195], a[136:139], a[32:35]
v_mfma_f32_16x16x32_bf16 a[64:67], v[192:195], a[140:143], a[64:67]
v_mfma_f32_16x16x32_bf16 a[4:7], v[196:199], a[132:135], a[4:7]
v_mfma_f32_16x16x32_bf16 a[36:39], v[196:199], a[136:139], a[36:39]
v_mfma_f32_16x16x32_bf16 a[68:71], v[196:199], a[140:143], a[68:71]
v_mfma_f32_16x16x32_bf16 a[8:11], v[200:203], a[132:135], a[8:11]
v_mfma_f32_16x16x32_bf16 a[40:43], v[200:203], a[136:139], a[40:43]
v_mfma_f32_16x16x32_bf16 a[72:75], v[200:203], a[140:143], a[72:75]
v_mfma_f32_16x16x32_bf16 a[12:15], v[204:207], a[132:135], a[12:15]
v_mfma_f32_16x16x32_bf16 a[44:47], v[204:207], a[136:139], a[44:47]
v_mfma_f32_16x16x32_bf16 a[76:79], v[204:207], a[140:143], a[76:79]
v_mfma_f32_16x16x32_bf16 a[16:19], v[208:211], a[132:135], a[16:19]
v_mfma_f32_16x16x32_bf16 a[48:51], v[208:211], a[136:139], a[48:51]
v_mfma_f32_16x16x32_bf16 a[80:83], v[208:211], a[140:143], a[80:83]
v_mfma_f32_16x16x32_bf16 a[20:23], v[212:215], a[132:135], a[20:23]
v_mfma_f32_16x16x32_bf16 a[52:55], v[212:215], a[136:139], a[52:55]
v_mfma_f32_16x16x32_bf16 a[84:87], v[212:215], a[140:143], a[84:87]
v_mfma_f32_16x16x32_bf16 a[24:27], v[216:219], a[132:135], a[24:27]
v_mfma_f32_16x16x32_bf16 a[56:59], v[216:219], a[136:139], a[56:59]
v_mfma_f32_16x16x32_bf16 a[88:91], v[216:219], a[140:143], a[88:91]
v_mfma_f32_16x16x32_bf16 a[28:31], v[220:223], a[132:135], a[28:31]
v_mfma_f32_16x16x32_bf16 a[60:63], v[220:223], a[136:139], a[60:63]
v_mfma_f32_16x16x32_bf16 a[92:95], v[220:223], a[140:143], a[92:95]
s_add_u32 s92, s75, 18
s_and_b32 s92, s92, 7
s_add_u32 s92, s92, 16
s_lshl_b32 s93, s92, 10
s_add_u32 s80, s72, s93
buffer_load_dwordx4 a[132:135], v5, s[44:47], s80 offen
buffer_load_dwordx4 a[136:139], v6, s[44:47], s80 offen
buffer_load_dwordx4 a[140:143], v7, s[44:47], s80 offen
s_mul_i32 s93, s92, 40960
s_add_u32 s81, s73, s93
buffer_load_dwordx4 v[128:131], v11, s[48:51], s81 offen
buffer_load_dwordx4 v[132:135], v11, s[48:51], s81 offen offset:1280
buffer_load_dwordx4 v[136:139], v11, s[48:51], s81 offen offset:2560
buffer_load_dwordx4 v[140:143], v11, s[48:51], s81 offen offset:3840
buffer_load_dwordx4 v[144:147], v12, s[48:51], s81 offen
buffer_load_dwordx4 v[148:151], v12, s[48:51], s81 offen offset:1280
buffer_load_dwordx4 v[152:155], v12, s[48:51], s81 offen offset:2560
buffer_load_dwordx4 v[156:159], v12, s[48:51], s81 offen offset:3840
s_waitcnt vmcnt(44)
v_perm_b32 v192, v164, v160, s11
v_perm_b32 v193, v172, v168, s11
v_perm_b32 v194, v180, v176, s11
v_perm_b32 v195, v188, v184, s11
v_perm_b32 v196, v164, v160, s12
v_perm_b32 v197, v172, v168, s12
v_perm_b32 v198, v180, v176, s12
v_perm_b32 v199, v188, v184, s12
v_perm_b32 v200, v165, v161, s11
v_perm_b32 v201, v173, v169, s11
v_perm_b32 v202, v181, v177, s11
v_perm_b32 v203, v189, v185, s11
v_perm_b32 v204, v165, v161, s12
v_perm_b32 v205, v173, v169, s12
v_perm_b32 v206, v181, v177, s12
v_perm_b32 v207, v189, v185, s12
v_perm_b32 v208, v166, v162, s11
v_perm_b32 v209, v174, v170, s11
v_perm_b32 v210, v182, v178, s11
v_perm_b32 v211, v190, v186, s11
v_perm_b32 v212, v166, v162, s12
v_perm_b32 v213, v174, v170, s12
v_perm_b32 v214, v182, v178, s12
v_perm_b32 v215, v190, v186, s12
v_perm_b32 v216, v167, v163, s11
v_perm_b32 v217, v175, v171, s11
v_perm_b32 v218, v183, v179, s11
v_perm_b32 v219, v191, v187, s11
v_perm_b32 v220, v167, v163, s12
v_perm_b32 v221, v175, v171, s12
v_perm_b32 v222, v183, v179, s12
v_perm_b32 v223, v191, v187, s12
v_mfma_f32_16x16x32_bf16 a[0:3], v[192:195], a[144:147], a[0:3]
v_mfma_f32_16x16x32_bf16 a[32:35], v[192:195], a[148:151], a[32:35]
v_mfma_f32_16x16x32_bf16 a[64:67], v[192:195], a[152:155], a[64:67]
v_mfma_f32_16x16x32_bf16 a[4:7], v[196:199], a[144:147], a[4:7]
v_mfma_f32_16x16x32_bf16 a[36:39], v[196:199], a[148:151], a[36:39]
v_mfma_f32_16x16x32_bf16 a[68:71], v[196:199], a[152:155], a[68:71]
v_mfma_f32_16x16x32_bf16 a[8:11], v[200:203], a[144:147], a[8:11]
v_mfma_f32_16x16x32_bf16 a[40:43], v[200:203], a[148:151], a[40:43]
v_mfma_f32_16x16x32_bf16 a[72:75], v[200:203], a[152:155], a[72:75]
v_mfma_f32_16x16x32_bf16 a[12:15], v[204:207], a[144:147], a[12:15]
v_mfma_f32_16x16x32_bf16 a[44:47], v[204:207], a[148:151], a[44:47]
v_mfma_f32_16x16x32_bf16 a[76:79], v[204:207], a[152:155], a[76:79]
v_mfma_f32_16x16x32_bf16 a[16:19], v[208:211], a[144:147], a[16:19]
v_mfma_f32_16x16x32_bf16 a[48:51], v[208:211], a[148:151], a[48:51]
v_mfma_f32_16x16x32_bf16 a[80:83], v[208:211], a[152:155], a[80:83]
v_mfma_f32_16x16x32_bf16 a[20:23], v[212:215], a[144:147], a[20:23]
v_mfma_f32_16x16x32_bf16 a[52:55], v[212:215], a[148:151], a[52:55]
v_mfma_f32_16x16x32_bf16 a[84:87], v[212:215], a[152:155], a[84:87]
v_mfma_f32_16x16x32_bf16 a[24:27], v[216:219], a[144:147], a[24:27]
v_mfma_f32_16x16x32_bf16 a[56:59], v[216:219], a[148:151], a[56:59]
v_mfma_f32_16x16x32_bf16 a[88:91], v[216:219], a[152:155], a[88:91]
v_mfma_f32_16x16x32_bf16 a[28:31], v[220:223], a[144:147], a[28:31]
v_mfma_f32_16x16x32_bf16 a[60:63], v[220:223], a[148:151], a[60:63]
v_mfma_f32_16x16x32_bf16 a[92:95], v[220:223], a[152:155], a[92:95]
s_add_u32 s92, s75, 19
s_and_b32 s92, s92, 7
s_add_u32 s92, s92, 16
s_lshl_b32 s93, s92, 10
s_add_u32 s82, s72, s93
buffer_load_dwordx4 a[144:147], v5, s[44:47], s82 offen
buffer_load_dwordx4 a[148:151], v6, s[44:47], s82 offen
buffer_load_dwordx4 a[152:155], v7, s[44:47], s82 offen
s_mul_i32 s93, s92, 40960
s_add_u32 s83, s73, s93
buffer_load_dwordx4 v[160:163], v11, s[48:51], s83 offen
buffer_load_dwordx4 v[164:167], v11, s[48:51], s83 offen offset:1280
buffer_load_dwordx4 v[168:171], v11, s[48:51], s83 offen offset:2560
buffer_load_dwordx4 v[172:175], v11, s[48:51], s83 offen offset:3840
buffer_load_dwordx4 v[176:179], v12, s[48:51], s83 offen
buffer_load_dwordx4 v[180:183], v12, s[48:51], s83 offen offset:1280
buffer_load_dwordx4 v[184:187], v12, s[48:51], s83 offen offset:2560
buffer_load_dwordx4 v[188:191], v12, s[48:51], s83 offen offset:3840
s_waitcnt vmcnt(44)
v_perm_b32 v192, v36, v32, s11
v_perm_b32 v193, v44, v40, s11
v_perm_b32 v194, v52, v48, s11
v_perm_b32 v195, v60, v56, s11
v_perm_b32 v196, v36, v32, s12
v_perm_b32 v197, v44, v40, s12
v_perm_b32 v198, v52, v48, s12
v_perm_b32 v199, v60, v56, s12
v_perm_b32 v200, v37, v33, s11
v_perm_b32 v201, v45, v41, s11
v_perm_b32 v202, v53, v49, s11
v_perm_b32 v203, v61, v57, s11
v_perm_b32 v204, v37, v33, s12
v_perm_b32 v205, v45, v41, s12
v_perm_b32 v206, v53, v49, s12
v_perm_b32 v207, v61, v57, s12
v_perm_b32 v208, v38, v34, s11
v_perm_b32 v209, v46, v42, s11
v_perm_b32 v210, v54, v50, s11
v_perm_b32 v211, v62, v58, s11
v_perm_b32 v212, v38, v34, s12
v_perm_b32 v213, v46, v42, s12
v_perm_b32 v214, v54, v50, s12
v_perm_b32 v215, v62, v58, s12
v_perm_b32 v216, v39, v35, s11
v_perm_b32 v217, v47, v43, s11
v_perm_b32 v218, v55, v51, s11
v_perm_b32 v219, v63, v59, s11
v_perm_b32 v220, v39, v35, s12
v_perm_b32 v221, v47, v43, s12
v_perm_b32 v222, v55, v51, s12
v_perm_b32 v223, v63, v59, s12
v_mfma_f32_16x16x32_bf16 a[0:3], v[192:195], a[96:99], a[0:3]
v_mfma_f32_16x16x32_bf16 a[32:35], v[192:195], a[100:103], a[32:35]
v_mfma_f32_16x16x32_bf16 a[64:67], v[192:195], a[104:107], a[64:67]
v_mfma_f32_16x16x32_bf16 a[4:7], v[196:199], a[96:99], a[4:7]
v_mfma_f32_16x16x32_bf16 a[36:39], v[196:199], a[100:103], a[36:39]
v_mfma_f32_16x16x32_bf16 a[68:71], v[196:199], a[104:107], a[68:71]
v_mfma_f32_16x16x32_bf16 a[8:11], v[200:203], a[96:99], a[8:11]
v_mfma_f32_16x16x32_bf16 a[40:43], v[200:203], a[100:103], a[40:43]
v_mfma_f32_16x16x32_bf16 a[72:75], v[200:203], a[104:107], a[72:75]
v_mfma_f32_16x16x32_bf16 a[12:15], v[204:207], a[96:99], a[12:15]
v_mfma_f32_16x16x32_bf16 a[44:47], v[204:207], a[100:103], a[44:47]
v_mfma_f32_16x16x32_bf16 a[76:79], v[204:207], a[104:107], a[76:79]
v_mfma_f32_16x16x32_bf16 a[16:19], v[208:211], a[96:99], a[16:19]
v_mfma_f32_16x16x32_bf16 a[48:51], v[208:211], a[100:103], a[48:51]
v_mfma_f32_16x16x32_bf16 a[80:83], v[208:211], a[104:107], a[80:83]
v_mfma_f32_16x16x32_bf16 a[20:23], v[212:215], a[96:99], a[20:23]
v_mfma_f32_16x16x32_bf16 a[52:55], v[212:215], a[100:103], a[52:55]
v_mfma_f32_16x16x32_bf16 a[84:87], v[212:215], a[104:107], a[84:87]
v_mfma_f32_16x16x32_bf16 a[24:27], v[216:219], a[96:99], a[24:27]
v_mfma_f32_16x16x32_bf16 a[56:59], v[216:219], a[100:103], a[56:59]
v_mfma_f32_16x16x32_bf16 a[88:91], v[216:219], a[104:107], a[88:91]
v_mfma_f32_16x16x32_bf16 a[28:31], v[220:223], a[96:99], a[28:31]
v_mfma_f32_16x16x32_bf16 a[60:63], v[220:223], a[100:103], a[60:63]
v_mfma_f32_16x16x32_bf16 a[92:95], v[220:223], a[104:107], a[92:95]
s_add_u32 s92, s75, 20
s_and_b32 s92, s92, 7
s_add_u32 s92, s92, 16
s_lshl_b32 s93, s92, 10
s_add_u32 s76, s72, s93
buffer_load_dwordx4 a[96:99], v5, s[44:47], s76 offen
buffer_load_dwordx4 a[100:103], v6, s[44:47], s76 offen
buffer_load_dwordx4 a[104:107], v7, s[44:47], s76 offen
s_mul_i32 s93, s92, 40960
s_add_u32 s77, s73, s93
buffer_load_dwordx4 v[32:35], v11, s[48:51], s77 offen
buffer_load_dwordx4 v[36:39], v11, s[48:51], s77 offen offset:1280
buffer_load_dwordx4 v[40:43], v11, s[48:51], s77 offen offset:2560
buffer_load_dwordx4 v[44:47], v11, s[48:51], s77 offen offset:3840
buffer_load_dwordx4 v[48:51], v12, s[48:51], s77 offen
buffer_load_dwordx4 v[52:55], v12, s[48:51], s77 offen offset:1280
buffer_load_dwordx4 v[56:59], v12, s[48:51], s77 offen offset:2560
buffer_load_dwordx4 v[60:63], v12, s[48:51], s77 offen offset:3840
s_waitcnt vmcnt(44)
v_perm_b32 v192, v68, v64, s11
v_perm_b32 v193, v76, v72, s11
v_perm_b32 v194, v84, v80, s11
v_perm_b32 v195, v92, v88, s11
v_perm_b32 v196, v68, v64, s12
v_perm_b32 v197, v76, v72, s12
v_perm_b32 v198, v84, v80, s12
v_perm_b32 v199, v92, v88, s12
v_perm_b32 v200, v69, v65, s11
v_perm_b32 v201, v77, v73, s11
v_perm_b32 v202, v85, v81, s11
v_perm_b32 v203, v93, v89, s11
v_perm_b32 v204, v69, v65, s12
v_perm_b32 v205, v77, v73, s12
v_perm_b32 v206, v85, v81, s12
v_perm_b32 v207, v93, v89, s12
v_perm_b32 v208, v70, v66, s11
v_perm_b32 v209, v78, v74, s11
v_perm_b32 v210, v86, v82, s11
v_perm_b32 v211, v94, v90, s11
v_perm_b32 v212, v70, v66, s12
v_perm_b32 v213, v78, v74, s12
v_perm_b32 v214, v86, v82, s12
v_perm_b32 v215, v94, v90, s12
v_perm_b32 v216, v71, v67, s11
v_perm_b32 v217, v79, v75, s11
v_perm_b32 v218, v87, v83, s11
v_perm_b32 v219, v95, v91, s11
v_perm_b32 v220, v71, v67, s12
v_perm_b32 v221, v79, v75, s12
v_perm_b32 v222, v87, v83, s12
v_perm_b32 v223, v95, v91, s12
v_mfma_f32_16x16x32_bf16 a[0:3], v[192:195], a[108:111], a[0:3]
v_mfma_f32_16x16x32_bf16 a[32:35], v[192:195], a[112:115], a[32:35]
v_mfma_f32_16x16x32_bf16 a[64:67], v[192:195], a[116:119], a[64:67]
v_mfma_f32_16x16x32_bf16 a[4:7], v[196:199], a[108:111], a[4:7]
v_mfma_f32_16x16x32_bf16 a[36:39], v[196:199], a[112:115], a[36:39]
v_mfma_f32_16x16x32_bf16 a[68:71], v[196:199], a[116:119], a[68:71]
v_mfma_f32_16x16x32_bf16 a[8:11], v[200:203], a[108:111], a[8:11]
v_mfma_f32_16x16x32_bf16 a[40:43], v[200:203], a[112:115], a[40:43]
v_mfma_f32_16x16x32_bf16 a[72:75], v[200:203], a[116:119], a[72:75]
v_mfma_f32_16x16x32_bf16 a[12:15], v[204:207], a[108:111], a[12:15]
v_mfma_f32_16x16x32_bf16 a[44:47], v[204:207], a[112:115], a[44:47]
v_mfma_f32_16x16x32_bf16 a[76:79], v[204:207], a[116:119], a[76:79]
v_mfma_f32_16x16x32_bf16 a[16:19], v[208:211], a[108:111], a[16:19]
v_mfma_f32_16x16x32_bf16 a[48:51], v[208:211], a[112:115], a[48:51]
v_mfma_f32_16x16x32_bf16 a[80:83], v[208:211], a[116:119], a[80:83]
v_mfma_f32_16x16x32_bf16 a[20:23], v[212:215], a[108:111], a[20:23]
v_mfma_f32_16x16x32_bf16 a[52:55], v[212:215], a[112:115], a[52:55]
v_mfma_f32_16x16x32_bf16 a[84:87], v[212:215], a[116:119], a[84:87]
v_mfma_f32_16x16x32_bf16 a[24:27], v[216:219], a[108:111], a[24:27]
v_mfma_f32_16x16x32_bf16 a[56:59], v[216:219], a[112:115], a[56:59]
v_mfma_f32_16x16x32_bf16 a[88:91], v[216:219], a[116:119], a[88:91]
v_mfma_f32_16x16x32_bf16 a[28:31], v[220:223], a[108:111], a[28:31]
v_mfma_f32_16x16x32_bf16 a[60:63], v[220:223], a[112:115], a[60:63]
v_mfma_f32_16x16x32_bf16 a[92:95], v[220:223], a[116:119], a[92:95]
s_add_u32 s92, s75, 21
s_and_b32 s92, s92, 7
s_add_u32 s92, s92, 16
s_lshl_b32 s93, s92, 10
s_add_u32 s78, s72, s93
buffer_load_dwordx4 a[108:111], v5, s[44:47], s78 offen
buffer_load_dwordx4 a[112:115], v6, s[44:47], s78 offen
buffer_load_dwordx4 a[116:119], v7, s[44:47], s78 offen
s_mul_i32 s93, s92, 40960
s_add_u32 s79, s73, s93
buffer_load_dwordx4 v[64:67], v11, s[48:51], s79 offen
buffer_load_dwordx4 v[68:71], v11, s[48:51], s79 offen offset:1280
buffer_load_dwordx4 v[72:75], v11, s[48:51], s79 offen offset:2560
buffer_load_dwordx4 v[76:79], v11, s[48:51], s79 offen offset:3840
buffer_load_dwordx4 v[80:83], v12, s[48:51], s79 offen
buffer_load_dwordx4 v[84:87], v12, s[48:51], s79 offen offset:1280
buffer_load_dwordx4 v[88:91], v12, s[48:51], s79 offen offset:2560
buffer_load_dwordx4 v[92:95], v12, s[48:51], s79 offen offset:3840
s_waitcnt vmcnt(44)
v_perm_b32 v192, v100, v96, s11
v_perm_b32 v193, v108, v104, s11
v_perm_b32 v194, v116, v112, s11
v_perm_b32 v195, v124, v120, s11
v_perm_b32 v196, v100, v96, s12
v_perm_b32 v197, v108, v104, s12
v_perm_b32 v198, v116, v112, s12
v_perm_b32 v199, v124, v120, s12
v_perm_b32 v200, v101, v97, s11
v_perm_b32 v201, v109, v105, s11
v_perm_b32 v202, v117, v113, s11
v_perm_b32 v203, v125, v121, s11
v_perm_b32 v204, v101, v97, s12
v_perm_b32 v205, v109, v105, s12
v_perm_b32 v206, v117, v113, s12
v_perm_b32 v207, v125, v121, s12
v_perm_b32 v208, v102, v98, s11
v_perm_b32 v209, v110, v106, s11
v_perm_b32 v210, v118, v114, s11
v_perm_b32 v211, v126, v122, s11
v_perm_b32 v212, v102, v98, s12
v_perm_b32 v213, v110, v106, s12
v_perm_b32 v214, v118, v114, s12
v_perm_b32 v215, v126, v122, s12
v_perm_b32 v216, v103, v99, s11
v_perm_b32 v217, v111, v107, s11
v_perm_b32 v218, v119, v115, s11
v_perm_b32 v219, v127, v123, s11
v_perm_b32 v220, v103, v99, s12
v_perm_b32 v221, v111, v107, s12
v_perm_b32 v222, v119, v115, s12
v_perm_b32 v223, v127, v123, s12
v_mfma_f32_16x16x32_bf16 a[0:3], v[192:195], a[120:123], a[0:3]
v_mfma_f32_16x16x32_bf16 a[32:35], v[192:195], a[124:127], a[32:35]
v_mfma_f32_16x16x32_bf16 a[64:67], v[192:195], a[128:131], a[64:67]
v_mfma_f32_16x16x32_bf16 a[4:7], v[196:199], a[120:123], a[4:7]
v_mfma_f32_16x16x32_bf16 a[36:39], v[196:199], a[124:127], a[36:39]
v_mfma_f32_16x16x32_bf16 a[68:71], v[196:199], a[128:131], a[68:71]
v_mfma_f32_16x16x32_bf16 a[8:11], v[200:203], a[120:123], a[8:11]
v_mfma_f32_16x16x32_bf16 a[40:43], v[200:203], a[124:127], a[40:43]
v_mfma_f32_16x16x32_bf16 a[72:75], v[200:203], a[128:131], a[72:75]
v_mfma_f32_16x16x32_bf16 a[12:15], v[204:207], a[120:123], a[12:15]
v_mfma_f32_16x16x32_bf16 a[44:47], v[204:207], a[124:127], a[44:47]
v_mfma_f32_16x16x32_bf16 a[76:79], v[204:207], a[128:131], a[76:79]
v_mfma_f32_16x16x32_bf16 a[16:19], v[208:211], a[120:123], a[16:19]
v_mfma_f32_16x16x32_bf16 a[48:51], v[208:211], a[124:127], a[48:51]
v_mfma_f32_16x16x32_bf16 a[80:83], v[208:211], a[128:131], a[80:83]
v_mfma_f32_16x16x32_bf16 a[20:23], v[212:215], a[120:123], a[20:23]
v_mfma_f32_16x16x32_bf16 a[52:55], v[212:215], a[124:127], a[52:55]
v_mfma_f32_16x16x32_bf16 a[84:87], v[212:215], a[128:131], a[84:87]
v_mfma_f32_16x16x32_bf16 a[24:27], v[216:219], a[120:123], a[24:27]
v_mfma_f32_16x16x32_bf16 a[56:59], v[216:219], a[124:127], a[56:59]
v_mfma_f32_16x16x32_bf16 a[88:91], v[216:219], a[128:131], a[88:91]
v_mfma_f32_16x16x32_bf16 a[28:31], v[220:223], a[120:123], a[28:31]
v_mfma_f32_16x16x32_bf16 a[60:63], v[220:223], a[124:127], a[60:63]
v_mfma_f32_16x16x32_bf16 a[92:95], v[220:223], a[128:131], a[92:95]
s_add_u32 s92, s75, 22
s_and_b32 s92, s92, 7
s_add_u32 s92, s92, 16
s_lshl_b32 s93, s92, 10
s_add_u32 s80, s72, s93
buffer_load_dwordx4 a[120:123], v5, s[44:47], s80 offen
buffer_load_dwordx4 a[124:127], v6, s[44:47], s80 offen
buffer_load_dwordx4 a[128:131], v7, s[44:47], s80 offen
s_mul_i32 s93, s92, 40960
s_add_u32 s81, s73, s93
buffer_load_dwordx4 v[96:99], v11, s[48:51], s81 offen
buffer_load_dwordx4 v[100:103], v11, s[48:51], s81 offen offset:1280
buffer_load_dwordx4 v[104:107], v11, s[48:51], s81 offen offset:2560
buffer_load_dwordx4 v[108:111], v11, s[48:51], s81 offen offset:3840
buffer_load_dwordx4 v[112:115], v12, s[48:51], s81 offen
buffer_load_dwordx4 v[116:119], v12, s[48:51], s81 offen offset:1280
buffer_load_dwordx4 v[120:123], v12, s[48:51], s81 offen offset:2560
buffer_load_dwordx4 v[124:127], v12, s[48:51], s81 offen offset:3840
s_waitcnt vmcnt(44)
v_perm_b32 v192, v132, v128, s11
v_perm_b32 v193, v140, v136, s11
v_perm_b32 v194, v148, v144, s11
v_perm_b32 v195, v156, v152, s11
v_perm_b32 v196, v132, v128, s12
v_perm_b32 v197, v140, v136, s12
v_perm_b32 v198, v148, v144, s12
v_perm_b32 v199, v156, v152, s12
v_perm_b32 v200, v133, v129, s11
v_perm_b32 v201, v141, v137, s11
v_perm_b32 v202, v149, v145, s11
v_perm_b32 v203, v157, v153, s11
v_perm_b32 v204, v133, v129, s12
v_perm_b32 v205, v141, v137, s12
v_perm_b32 v206, v149, v145, s12
v_perm_b32 v207, v157, v153, s12
v_perm_b32 v208, v134, v130, s11
v_perm_b32 v209, v142, v138, s11
v_perm_b32 v210, v150, v146, s11
v_perm_b32 v211, v158, v154, s11
v_perm_b32 v212, v134, v130, s12
v_perm_b32 v213, v142, v138, s12
v_perm_b32 v214, v150, v146, s12
v_perm_b32 v215, v158, v154, s12
v_perm_b32 v216, v135, v131, s11
v_perm_b32 v217, v143, v139, s11
v_perm_b32 v218, v151, v147, s11
v_perm_b32 v219, v159, v155, s11
v_perm_b32 v220, v135, v131, s12
v_perm_b32 v221, v143, v139, s12
v_perm_b32 v222, v151, v147, s12
v_perm_b32 v223, v159, v155, s12
v_mfma_f32_16x16x32_bf16 a[0:3], v[192:195], a[132:135], a[0:3]
v_mfma_f32_16x16x32_bf16 a[32:35], v[192:195], a[136:139], a[32:35]
v_mfma_f32_16x16x32_bf16 a[64:67], v[192:195], a[140:143], a[64:67]
v_mfma_f32_16x16x32_bf16 a[4:7], v[196:199], a[132:135], a[4:7]
v_mfma_f32_16x16x32_bf16 a[36:39], v[196:199], a[136:139], a[36:39]
v_mfma_f32_16x16x32_bf16 a[68:71], v[196:199], a[140:143], a[68:71]
v_mfma_f32_16x16x32_bf16 a[8:11], v[200:203], a[132:135], a[8:11]
v_mfma_f32_16x16x32_bf16 a[40:43], v[200:203], a[136:139], a[40:43]
v_mfma_f32_16x16x32_bf16 a[72:75], v[200:203], a[140:143], a[72:75]
v_mfma_f32_16x16x32_bf16 a[12:15], v[204:207], a[132:135], a[12:15]
v_mfma_f32_16x16x32_bf16 a[44:47], v[204:207], a[136:139], a[44:47]
v_mfma_f32_16x16x32_bf16 a[76:79], v[204:207], a[140:143], a[76:79]
v_mfma_f32_16x16x32_bf16 a[16:19], v[208:211], a[132:135], a[16:19]
v_mfma_f32_16x16x32_bf16 a[48:51], v[208:211], a[136:139], a[48:51]
v_mfma_f32_16x16x32_bf16 a[80:83], v[208:211], a[140:143], a[80:83]
v_mfma_f32_16x16x32_bf16 a[20:23], v[212:215], a[132:135], a[20:23]
v_mfma_f32_16x16x32_bf16 a[52:55], v[212:215], a[136:139], a[52:55]
v_mfma_f32_16x16x32_bf16 a[84:87], v[212:215], a[140:143], a[84:87]
v_mfma_f32_16x16x32_bf16 a[24:27], v[216:219], a[132:135], a[24:27]
v_mfma_f32_16x16x32_bf16 a[56:59], v[216:219], a[136:139], a[56:59]
v_mfma_f32_16x16x32_bf16 a[88:91], v[216:219], a[140:143], a[88:91]
v_mfma_f32_16x16x32_bf16 a[28:31], v[220:223], a[132:135], a[28:31]
v_mfma_f32_16x16x32_bf16 a[60:63], v[220:223], a[136:139], a[60:63]
v_mfma_f32_16x16x32_bf16 a[92:95], v[220:223], a[140:143], a[92:95]
s_add_u32 s92, s75, 23
s_and_b32 s92, s92, 7
s_add_u32 s92, s92, 16
s_lshl_b32 s93, s92, 10
s_add_u32 s82, s72, s93
buffer_load_dwordx4 a[132:135], v5, s[44:47], s82 offen
buffer_load_dwordx4 a[136:139], v6, s[44:47], s82 offen
buffer_load_dwordx4 a[140:143], v7, s[44:47], s82 offen
s_mul_i32 s93, s92, 40960
s_add_u32 s83, s73, s93
buffer_load_dwordx4 v[128:131], v11, s[48:51], s83 offen
buffer_load_dwordx4 v[132:135], v11, s[48:51], s83 offen offset:1280
buffer_load_dwordx4 v[136:139], v11, s[48:51], s83 offen offset:2560
buffer_load_dwordx4 v[140:143], v11, s[48:51], s83 offen offset:3840
buffer_load_dwordx4 v[144:147], v12, s[48:51], s83 offen
buffer_load_dwordx4 v[148:151], v12, s[48:51], s83 offen offset:1280
buffer_load_dwordx4 v[152:155], v12, s[48:51], s83 offen offset:2560
buffer_load_dwordx4 v[156:159], v12, s[48:51], s83 offen offset:3840
s_waitcnt vmcnt(44)
v_perm_b32 v192, v164, v160, s11
v_perm_b32 v193, v172, v168, s11
v_perm_b32 v194, v180, v176, s11
v_perm_b32 v195, v188, v184, s11
v_perm_b32 v196, v164, v160, s12
v_perm_b32 v197, v172, v168, s12
v_perm_b32 v198, v180, v176, s12
v_perm_b32 v199, v188, v184, s12
v_perm_b32 v200, v165, v161, s11
v_perm_b32 v201, v173, v169, s11
v_perm_b32 v202, v181, v177, s11
v_perm_b32 v203, v189, v185, s11
v_perm_b32 v204, v165, v161, s12
v_perm_b32 v205, v173, v169, s12
v_perm_b32 v206, v181, v177, s12
v_perm_b32 v207, v189, v185, s12
v_perm_b32 v208, v166, v162, s11
v_perm_b32 v209, v174, v170, s11
v_perm_b32 v210, v182, v178, s11
v_perm_b32 v211, v190, v186, s11
v_perm_b32 v212, v166, v162, s12
v_perm_b32 v213, v174, v170, s12
v_perm_b32 v214, v182, v178, s12
v_perm_b32 v215, v190, v186, s12
v_perm_b32 v216, v167, v163, s11
v_perm_b32 v217, v175, v171, s11
v_perm_b32 v218, v183, v179, s11
v_perm_b32 v219, v191, v187, s11
v_perm_b32 v220, v167, v163, s12
v_perm_b32 v221, v175, v171, s12
v_perm_b32 v222, v183, v179, s12
v_perm_b32 v223, v191, v187, s12
v_mfma_f32_16x16x32_bf16 a[0:3], v[192:195], a[144:147], a[0:3]
v_mfma_f32_16x16x32_bf16 a[32:35], v[192:195], a[148:151], a[32:35]
v_mfma_f32_16x16x32_bf16 a[64:67], v[192:195], a[152:155], a[64:67]
v_mfma_f32_16x16x32_bf16 a[4:7], v[196:199], a[144:147], a[4:7]
v_mfma_f32_16x16x32_bf16 a[36:39], v[196:199], a[148:151], a[36:39]
v_mfma_f32_16x16x32_bf16 a[68:71], v[196:199], a[152:155], a[68:71]
v_mfma_f32_16x16x32_bf16 a[8:11], v[200:203], a[144:147], a[8:11]
v_mfma_f32_16x16x32_bf16 a[40:43], v[200:203], a[148:151], a[40:43]
v_mfma_f32_16x16x32_bf16 a[72:75], v[200:203], a[152:155], a[72:75]
v_mfma_f32_16x16x32_bf16 a[12:15], v[204:207], a[144:147], a[12:15]
v_mfma_f32_16x16x32_bf16 a[44:47], v[204:207], a[148:151], a[44:47]
v_mfma_f32_16x16x32_bf16 a[76:79], v[204:207], a[152:155], a[76:79]
v_mfma_f32_16x16x32_bf16 a[16:19], v[208:211], a[144:147], a[16:19]
v_mfma_f32_16x16x32_bf16 a[48:51], v[208:211], a[148:151], a[48:51]
v_mfma_f32_16x16x32_bf16 a[80:83], v[208:211], a[152:155], a[80:83]
v_mfma_f32_16x16x32_bf16 a[20:23], v[212:215], a[144:147], a[20:23]
v_mfma_f32_16x16x32_bf16 a[52:55], v[212:215], a[148:151], a[52:55]
v_mfma_f32_16x16x32_bf16 a[84:87], v[212:215], a[152:155], a[84:87]
v_mfma_f32_16x16x32_bf16 a[24:27], v[216:219], a[144:147], a[24:27]
v_mfma_f32_16x16x32_bf16 a[56:59], v[216:219], a[148:151], a[56:59]
v_mfma_f32_16x16x32_bf16 a[88:91], v[216:219], a[152:155], a[88:91]
v_mfma_f32_16x16x32_bf16 a[28:31], v[220:223], a[144:147], a[28:31]
v_mfma_f32_16x16x32_bf16 a[60:63], v[220:223], a[148:151], a[60:63]
v_mfma_f32_16x16x32_bf16 a[92:95], v[220:223], a[152:155], a[92:95]
s_add_u32 s92, s75, 24
s_and_b32 s92, s92, 7
s_add_u32 s92, s92, 24
s_lshl_b32 s93, s92, 10
s_add_u32 s76, s72, s93
buffer_load_dwordx4 a[144:147], v5, s[44:47], s76 offen
buffer_load_dwordx4 a[148:151], v6, s[44:47], s76 offen
buffer_load_dwordx4 a[152:155], v7, s[44:47], s76 offen
s_mul_i32 s93, s92, 40960
s_add_u32 s77, s73, s93
buffer_load_dwordx4 v[160:163], v11, s[48:51], s77 offen
buffer_load_dwordx4 v[164:167], v11, s[48:51], s77 offen offset:1280
buffer_load_dwordx4 v[168:171], v11, s[48:51], s77 offen offset:2560
buffer_load_dwordx4 v[172:175], v11, s[48:51], s77 offen offset:3840
buffer_load_dwordx4 v[176:179], v12, s[48:51], s77 offen
buffer_load_dwordx4 v[180:183], v12, s[48:51], s77 offen offset:1280
buffer_load_dwordx4 v[184:187], v12, s[48:51], s77 offen offset:2560
buffer_load_dwordx4 v[188:191], v12, s[48:51], s77 offen offset:3840
s_waitcnt vmcnt(44)
v_perm_b32 v192, v36, v32, s11
v_perm_b32 v193, v44, v40, s11
v_perm_b32 v194, v52, v48, s11
v_perm_b32 v195, v60, v56, s11
v_perm_b32 v196, v36, v32, s12
v_perm_b32 v197, v44, v40, s12
v_perm_b32 v198, v52, v48, s12
v_perm_b32 v199, v60, v56, s12
v_perm_b32 v200, v37, v33, s11
v_perm_b32 v201, v45, v41, s11
v_perm_b32 v202, v53, v49, s11
v_perm_b32 v203, v61, v57, s11
v_perm_b32 v204, v37, v33, s12
v_perm_b32 v205, v45, v41, s12
v_perm_b32 v206, v53, v49, s12
v_perm_b32 v207, v61, v57, s12
v_perm_b32 v208, v38, v34, s11
v_perm_b32 v209, v46, v42, s11
v_perm_b32 v210, v54, v50, s11
v_perm_b32 v211, v62, v58, s11
v_perm_b32 v212, v38, v34, s12
v_perm_b32 v213, v46, v42, s12
v_perm_b32 v214, v54, v50, s12
v_perm_b32 v215, v62, v58, s12
v_perm_b32 v216, v39, v35, s11
v_perm_b32 v217, v47, v43, s11
v_perm_b32 v218, v55, v51, s11
v_perm_b32 v219, v63, v59, s11
v_perm_b32 v220, v39, v35, s12
v_perm_b32 v221, v47, v43, s12
v_perm_b32 v222, v55, v51, s12
v_perm_b32 v223, v63, v59, s12
v_mfma_f32_16x16x32_bf16 a[0:3], v[192:195], a[96:99], a[0:3]
v_mfma_f32_16x16x32_bf16 a[32:35], v[192:195], a[100:103], a[32:35]
v_mfma_f32_16x16x32_bf16 a[64:67], v[192:195], a[104:107], a[64:67]
v_mfma_f32_16x16x32_bf16 a[4:7], v[196:199], a[96:99], a[4:7]
v_mfma_f32_16x16x32_bf16 a[36:39], v[196:199], a[100:103], a[36:39]
v_mfma_f32_16x16x32_bf16 a[68:71], v[196:199], a[104:107], a[68:71]
v_mfma_f32_16x16x32_bf16 a[8:11], v[200:203], a[96:99], a[8:11]
v_mfma_f32_16x16x32_bf16 a[40:43], v[200:203], a[100:103], a[40:43]
v_mfma_f32_16x16x32_bf16 a[72:75], v[200:203], a[104:107], a[72:75]
v_mfma_f32_16x16x32_bf16 a[12:15], v[204:207], a[96:99], a[12:15]
v_mfma_f32_16x16x32_bf16 a[44:47], v[204:207], a[100:103], a[44:47]
v_mfma_f32_16x16x32_bf16 a[76:79], v[204:207], a[104:107], a[76:79]
v_mfma_f32_16x16x32_bf16 a[16:19], v[208:211], a[96:99], a[16:19]
v_mfma_f32_16x16x32_bf16 a[48:51], v[208:211], a[100:103], a[48:51]
v_mfma_f32_16x16x32_bf16 a[80:83], v[208:211], a[104:107], a[80:83]
v_mfma_f32_16x16x32_bf16 a[20:23], v[212:215], a[96:99], a[20:23]
v_mfma_f32_16x16x32_bf16 a[52:55], v[212:215], a[100:103], a[52:55]
v_mfma_f32_16x16x32_bf16 a[84:87], v[212:215], a[104:107], a[84:87]
v_mfma_f32_16x16x32_bf16 a[24:27], v[216:219], a[96:99], a[24:27]
v_mfma_f32_16x16x32_bf16 a[56:59], v[216:219], a[100:103], a[56:59]
v_mfma_f32_16x16x32_bf16 a[88:91], v[216:219], a[104:107], a[88:91]
v_mfma_f32_16x16x32_bf16 a[28:31], v[220:223], a[96:99], a[28:31]
v_mfma_f32_16x16x32_bf16 a[60:63], v[220:223], a[100:103], a[60:63]
v_mfma_f32_16x16x32_bf16 a[92:95], v[220:223], a[104:107], a[92:95]
s_add_u32 s92, s75, 25
s_and_b32 s92, s92, 7
s_add_u32 s92, s92, 24
s_lshl_b32 s93, s92, 10
s_add_u32 s78, s72, s93
buffer_load_dwordx4 a[96:99], v5, s[44:47], s78 offen
buffer_load_dwordx4 a[100:103], v6, s[44:47], s78 offen
buffer_load_dwordx4 a[104:107], v7, s[44:47], s78 offen
s_mul_i32 s93, s92, 40960
s_add_u32 s79, s73, s93
buffer_load_dwordx4 v[32:35], v11, s[48:51], s79 offen
buffer_load_dwordx4 v[36:39], v11, s[48:51], s79 offen offset:1280
buffer_load_dwordx4 v[40:43], v11, s[48:51], s79 offen offset:2560
buffer_load_dwordx4 v[44:47], v11, s[48:51], s79 offen offset:3840
buffer_load_dwordx4 v[48:51], v12, s[48:51], s79 offen
buffer_load_dwordx4 v[52:55], v12, s[48:51], s79 offen offset:1280
buffer_load_dwordx4 v[56:59], v12, s[48:51], s79 offen offset:2560
buffer_load_dwordx4 v[60:63], v12, s[48:51], s79 offen offset:3840
s_waitcnt vmcnt(44)
v_perm_b32 v192, v68, v64, s11
v_perm_b32 v193, v76, v72, s11
v_perm_b32 v194, v84, v80, s11
v_perm_b32 v195, v92, v88, s11
v_perm_b32 v196, v68, v64, s12
v_perm_b32 v197, v76, v72, s12
v_perm_b32 v198, v84, v80, s12
v_perm_b32 v199, v92, v88, s12
v_perm_b32 v200, v69, v65, s11
v_perm_b32 v201, v77, v73, s11
v_perm_b32 v202, v85, v81, s11
v_perm_b32 v203, v93, v89, s11
v_perm_b32 v204, v69, v65, s12
v_perm_b32 v205, v77, v73, s12
v_perm_b32 v206, v85, v81, s12
v_perm_b32 v207, v93, v89, s12
v_perm_b32 v208, v70, v66, s11
v_perm_b32 v209, v78, v74, s11
v_perm_b32 v210, v86, v82, s11
v_perm_b32 v211, v94, v90, s11
v_perm_b32 v212, v70, v66, s12
v_perm_b32 v213, v78, v74, s12
v_perm_b32 v214, v86, v82, s12
v_perm_b32 v215, v94, v90, s12
v_perm_b32 v216, v71, v67, s11
v_perm_b32 v217, v79, v75, s11
v_perm_b32 v218, v87, v83, s11
v_perm_b32 v219, v95, v91, s11
v_perm_b32 v220, v71, v67, s12
v_perm_b32 v221, v79, v75, s12
v_perm_b32 v222, v87, v83, s12
v_perm_b32 v223, v95, v91, s12
v_mfma_f32_16x16x32_bf16 a[0:3], v[192:195], a[108:111], a[0:3]
v_mfma_f32_16x16x32_bf16 a[32:35], v[192:195], a[112:115], a[32:35]
v_mfma_f32_16x16x32_bf16 a[64:67], v[192:195], a[116:119], a[64:67]
v_mfma_f32_16x16x32_bf16 a[4:7], v[196:199], a[108:111], a[4:7]
v_mfma_f32_16x16x32_bf16 a[36:39], v[196:199], a[112:115], a[36:39]
v_mfma_f32_16x16x32_bf16 a[68:71], v[196:199], a[116:119], a[68:71]
v_mfma_f32_16x16x32_bf16 a[8:11], v[200:203], a[108:111], a[8:11]
v_mfma_f32_16x16x32_bf16 a[40:43], v[200:203], a[112:115], a[40:43]
v_mfma_f32_16x16x32_bf16 a[72:75], v[200:203], a[116:119], a[72:75]
v_mfma_f32_16x16x32_bf16 a[12:15], v[204:207], a[108:111], a[12:15]
v_mfma_f32_16x16x32_bf16 a[44:47], v[204:207], a[112:115], a[44:47]
v_mfma_f32_16x16x32_bf16 a[76:79], v[204:207], a[116:119], a[76:79]
v_mfma_f32_16x16x32_bf16 a[16:19], v[208:211], a[108:111], a[16:19]
v_mfma_f32_16x16x32_bf16 a[48:51], v[208:211], a[112:115], a[48:51]
v_mfma_f32_16x16x32_bf16 a[80:83], v[208:211], a[116:119], a[80:83]
v_mfma_f32_16x16x32_bf16 a[20:23], v[212:215], a[108:111], a[20:23]
v_mfma_f32_16x16x32_bf16 a[52:55], v[212:215], a[112:115], a[52:55]
v_mfma_f32_16x16x32_bf16 a[84:87], v[212:215], a[116:119], a[84:87]
v_mfma_f32_16x16x32_bf16 a[24:27], v[216:219], a[108:111], a[24:27]
v_mfma_f32_16x16x32_bf16 a[56:59], v[216:219], a[112:115], a[56:59]
v_mfma_f32_16x16x32_bf16 a[88:91], v[216:219], a[116:119], a[88:91]
v_mfma_f32_16x16x32_bf16 a[28:31], v[220:223], a[108:111], a[28:31]
v_mfma_f32_16x16x32_bf16 a[60:63], v[220:223], a[112:115], a[60:63]
v_mfma_f32_16x16x32_bf16 a[92:95], v[220:223], a[116:119], a[92:95]
s_add_u32 s92, s75, 26
s_and_b32 s92, s92, 7
s_add_u32 s92, s92, 24
s_lshl_b32 s93, s92, 10
s_add_u32 s80, s72, s93
buffer_load_dwordx4 a[108:111], v5, s[44:47], s80 offen
buffer_load_dwordx4 a[112:115], v6, s[44:47], s80 offen
buffer_load_dwordx4 a[116:119], v7, s[44:47], s80 offen
s_mul_i32 s93, s92, 40960
s_add_u32 s81, s73, s93
buffer_load_dwordx4 v[64:67], v11, s[48:51], s81 offen
buffer_load_dwordx4 v[68:71], v11, s[48:51], s81 offen offset:1280
buffer_load_dwordx4 v[72:75], v11, s[48:51], s81 offen offset:2560
buffer_load_dwordx4 v[76:79], v11, s[48:51], s81 offen offset:3840
buffer_load_dwordx4 v[80:83], v12, s[48:51], s81 offen
buffer_load_dwordx4 v[84:87], v12, s[48:51], s81 offen offset:1280
buffer_load_dwordx4 v[88:91], v12, s[48:51], s81 offen offset:2560
buffer_load_dwordx4 v[92:95], v12, s[48:51], s81 offen offset:3840
s_waitcnt vmcnt(44)
v_perm_b32 v192, v100, v96, s11
v_perm_b32 v193, v108, v104, s11
v_perm_b32 v194, v116, v112, s11
v_perm_b32 v195, v124, v120, s11
v_perm_b32 v196, v100, v96, s12
v_perm_b32 v197, v108, v104, s12
v_perm_b32 v198, v116, v112, s12
v_perm_b32 v199, v124, v120, s12
v_perm_b32 v200, v101, v97, s11
v_perm_b32 v201, v109, v105, s11
v_perm_b32 v202, v117, v113, s11
v_perm_b32 v203, v125, v121, s11
v_perm_b32 v204, v101, v97, s12
v_perm_b32 v205, v109, v105, s12
v_perm_b32 v206, v117, v113, s12
v_perm_b32 v207, v125, v121, s12
v_perm_b32 v208, v102, v98, s11
v_perm_b32 v209, v110, v106, s11
v_perm_b32 v210, v118, v114, s11
v_perm_b32 v211, v126, v122, s11
v_perm_b32 v212, v102, v98, s12
v_perm_b32 v213, v110, v106, s12
v_perm_b32 v214, v118, v114, s12
v_perm_b32 v215, v126, v122, s12
v_perm_b32 v216, v103, v99, s11
v_perm_b32 v217, v111, v107, s11
v_perm_b32 v218, v119, v115, s11
v_perm_b32 v219, v127, v123, s11
v_perm_b32 v220, v103, v99, s12
v_perm_b32 v221, v111, v107, s12
v_perm_b32 v222, v119, v115, s12
v_perm_b32 v223, v127, v123, s12
v_mfma_f32_16x16x32_bf16 a[0:3], v[192:195], a[120:123], a[0:3]
v_mfma_f32_16x16x32_bf16 a[32:35], v[192:195], a[124:127], a[32:35]
v_mfma_f32_16x16x32_bf16 a[64:67], v[192:195], a[128:131], a[64:67]
v_mfma_f32_16x16x32_bf16 a[4:7], v[196:199], a[120:123], a[4:7]
v_mfma_f32_16x16x32_bf16 a[36:39], v[196:199], a[124:127], a[36:39]
v_mfma_f32_16x16x32_bf16 a[68:71], v[196:199], a[128:131], a[68:71]
v_mfma_f32_16x16x32_bf16 a[8:11], v[200:203], a[120:123], a[8:11]
v_mfma_f32_16x16x32_bf16 a[40:43], v[200:203], a[124:127], a[40:43]
v_mfma_f32_16x16x32_bf16 a[72:75], v[200:203], a[128:131], a[72:75]
v_mfma_f32_16x16x32_bf16 a[12:15], v[204:207], a[120:123], a[12:15]
v_mfma_f32_16x16x32_bf16 a[44:47], v[204:207], a[124:127], a[44:47]
v_mfma_f32_16x16x32_bf16 a[76:79], v[204:207], a[128:131], a[76:79]
v_mfma_f32_16x16x32_bf16 a[16:19], v[208:211], a[120:123], a[16:19]
v_mfma_f32_16x16x32_bf16 a[48:51], v[208:211], a[124:127], a[48:51]
v_mfma_f32_16x16x32_bf16 a[80:83], v[208:211], a[128:131], a[80:83]
v_mfma_f32_16x16x32_bf16 a[20:23], v[212:215], a[120:123], a[20:23]
v_mfma_f32_16x16x32_bf16 a[52:55], v[212:215], a[124:127], a[52:55]
v_mfma_f32_16x16x32_bf16 a[84:87], v[212:215], a[128:131], a[84:87]
v_mfma_f32_16x16x32_bf16 a[24:27], v[216:219], a[120:123], a[24:27]
v_mfma_f32_16x16x32_bf16 a[56:59], v[216:219], a[124:127], a[56:59]
v_mfma_f32_16x16x32_bf16 a[88:91], v[216:219], a[128:131], a[88:91]
v_mfma_f32_16x16x32_bf16 a[28:31], v[220:223], a[120:123], a[28:31]
v_mfma_f32_16x16x32_bf16 a[60:63], v[220:223], a[124:127], a[60:63]
v_mfma_f32_16x16x32_bf16 a[92:95], v[220:223], a[128:131], a[92:95]
s_add_u32 s92, s75, 27
s_and_b32 s92, s92, 7
s_add_u32 s92, s92, 24
s_lshl_b32 s93, s92, 10
s_add_u32 s82, s72, s93
buffer_load_dwordx4 a[120:123], v5, s[44:47], s82 offen
buffer_load_dwordx4 a[124:127], v6, s[44:47], s82 offen
buffer_load_dwordx4 a[128:131], v7, s[44:47], s82 offen
s_mul_i32 s93, s92, 40960
s_add_u32 s83, s73, s93
buffer_load_dwordx4 v[96:99], v11, s[48:51], s83 offen
buffer_load_dwordx4 v[100:103], v11, s[48:51], s83 offen offset:1280
buffer_load_dwordx4 v[104:107], v11, s[48:51], s83 offen offset:2560
buffer_load_dwordx4 v[108:111], v11, s[48:51], s83 offen offset:3840
buffer_load_dwordx4 v[112:115], v12, s[48:51], s83 offen
buffer_load_dwordx4 v[116:119], v12, s[48:51], s83 offen offset:1280
buffer_load_dwordx4 v[120:123], v12, s[48:51], s83 offen offset:2560
buffer_load_dwordx4 v[124:127], v12, s[48:51], s83 offen offset:3840
s_waitcnt vmcnt(44)
v_perm_b32 v192, v132, v128, s11
v_perm_b32 v193, v140, v136, s11
v_perm_b32 v194, v148, v144, s11
v_perm_b32 v195, v156, v152, s11
v_perm_b32 v196, v132, v128, s12
v_perm_b32 v197, v140, v136, s12
v_perm_b32 v198, v148, v144, s12
v_perm_b32 v199, v156, v152, s12
v_perm_b32 v200, v133, v129, s11
v_perm_b32 v201, v141, v137, s11
v_perm_b32 v202, v149, v145, s11
v_perm_b32 v203, v157, v153, s11
v_perm_b32 v204, v133, v129, s12
v_perm_b32 v205, v141, v137, s12
v_perm_b32 v206, v149, v145, s12
v_perm_b32 v207, v157, v153, s12
v_perm_b32 v208, v134, v130, s11
v_perm_b32 v209, v142, v138, s11
v_perm_b32 v210, v150, v146, s11
v_perm_b32 v211, v158, v154, s11
v_perm_b32 v212, v134, v130, s12
v_perm_b32 v213, v142, v138, s12
v_perm_b32 v214, v150, v146, s12
v_perm_b32 v215, v158, v154, s12
v_perm_b32 v216, v135, v131, s11
v_perm_b32 v217, v143, v139, s11
v_perm_b32 v218, v151, v147, s11
v_perm_b32 v219, v159, v155, s11
v_perm_b32 v220, v135, v131, s12
v_perm_b32 v221, v143, v139, s12
v_perm_b32 v222, v151, v147, s12
v_perm_b32 v223, v159, v155, s12
v_mfma_f32_16x16x32_bf16 a[0:3], v[192:195], a[132:135], a[0:3]
v_mfma_f32_16x16x32_bf16 a[32:35], v[192:195], a[136:139], a[32:35]
v_mfma_f32_16x16x32_bf16 a[64:67], v[192:195], a[140:143], a[64:67]
v_mfma_f32_16x16x32_bf16 a[4:7], v[196:199], a[132:135], a[4:7]
v_mfma_f32_16x16x32_bf16 a[36:39], v[196:199], a[136:139], a[36:39]
v_mfma_f32_16x16x32_bf16 a[68:71], v[196:199], a[140:143], a[68:71]
v_mfma_f32_16x16x32_bf16 a[8:11], v[200:203], a[132:135], a[8:11]
v_mfma_f32_16x16x32_bf16 a[40:43], v[200:203], a[136:139], a[40:43]
v_mfma_f32_16x16x32_bf16 a[72:75], v[200:203], a[140:143], a[72:75]
v_mfma_f32_16x16x32_bf16 a[12:15], v[204:207], a[132:135], a[12:15]
v_mfma_f32_16x16x32_bf16 a[44:47], v[204:207], a[136:139], a[44:47]
v_mfma_f32_16x16x32_bf16 a[76:79], v[204:207], a[140:143], a[76:79]
v_mfma_f32_16x16x32_bf16 a[16:19], v[208:211], a[132:135], a[16:19]
v_mfma_f32_16x16x32_bf16 a[48:51], v[208:211], a[136:139], a[48:51]
v_mfma_f32_16x16x32_bf16 a[80:83], v[208:211], a[140:143], a[80:83]
v_mfma_f32_16x16x32_bf16 a[20:23], v[212:215], a[132:135], a[20:23]
v_mfma_f32_16x16x32_bf16 a[52:55], v[212:215], a[136:139], a[52:55]
v_mfma_f32_16x16x32_bf16 a[84:87], v[212:215], a[140:143], a[84:87]
v_mfma_f32_16x16x32_bf16 a[24:27], v[216:219], a[132:135], a[24:27]
v_mfma_f32_16x16x32_bf16 a[56:59], v[216:219], a[136:139], a[56:59]
v_mfma_f32_16x16x32_bf16 a[88:91], v[216:219], a[140:143], a[88:91]
v_mfma_f32_16x16x32_bf16 a[28:31], v[220:223], a[132:135], a[28:31]
v_mfma_f32_16x16x32_bf16 a[60:63], v[220:223], a[136:139], a[60:63]
v_mfma_f32_16x16x32_bf16 a[92:95], v[220:223], a[140:143], a[92:95]
s_add_u32 s92, s75, 28
s_and_b32 s92, s92, 7
s_add_u32 s92, s92, 24
s_lshl_b32 s93, s92, 10
s_add_u32 s76, s72, s93
buffer_load_dwordx4 a[132:135], v5, s[44:47], s76 offen
buffer_load_dwordx4 a[136:139], v6, s[44:47], s76 offen
buffer_load_dwordx4 a[140:143], v7, s[44:47], s76 offen
s_mul_i32 s93, s92, 40960
s_add_u32 s77, s73, s93
buffer_load_dwordx4 v[128:131], v11, s[48:51], s77 offen
buffer_load_dwordx4 v[132:135], v11, s[48:51], s77 offen offset:1280
buffer_load_dwordx4 v[136:139], v11, s[48:51], s77 offen offset:2560
buffer_load_dwordx4 v[140:143], v11, s[48:51], s77 offen offset:3840
buffer_load_dwordx4 v[144:147], v12, s[48:51], s77 offen
buffer_load_dwordx4 v[148:151], v12, s[48:51], s77 offen offset:1280
buffer_load_dwordx4 v[152:155], v12, s[48:51], s77 offen offset:2560
buffer_load_dwordx4 v[156:159], v12, s[48:51], s77 offen offset:3840
s_waitcnt vmcnt(44)
v_perm_b32 v192, v164, v160, s11
v_perm_b32 v193, v172, v168, s11
v_perm_b32 v194, v180, v176, s11
v_perm_b32 v195, v188, v184, s11
v_perm_b32 v196, v164, v160, s12
v_perm_b32 v197, v172, v168, s12
v_perm_b32 v198, v180, v176, s12
v_perm_b32 v199, v188, v184, s12
v_perm_b32 v200, v165, v161, s11
v_perm_b32 v201, v173, v169, s11
v_perm_b32 v202, v181, v177, s11
v_perm_b32 v203, v189, v185, s11
v_perm_b32 v204, v165, v161, s12
v_perm_b32 v205, v173, v169, s12
v_perm_b32 v206, v181, v177, s12
v_perm_b32 v207, v189, v185, s12
v_perm_b32 v208, v166, v162, s11
v_perm_b32 v209, v174, v170, s11
v_perm_b32 v210, v182, v178, s11
v_perm_b32 v211, v190, v186, s11
v_perm_b32 v212, v166, v162, s12
v_perm_b32 v213, v174, v170, s12
v_perm_b32 v214, v182, v178, s12
v_perm_b32 v215, v190, v186, s12
v_perm_b32 v216, v167, v163, s11
v_perm_b32 v217, v175, v171, s11
v_perm_b32 v218, v183, v179, s11
v_perm_b32 v219, v191, v187, s11
v_perm_b32 v220, v167, v163, s12
v_perm_b32 v221, v175, v171, s12
v_perm_b32 v222, v183, v179, s12
v_perm_b32 v223, v191, v187, s12
v_mfma_f32_16x16x32_bf16 a[0:3], v[192:195], a[144:147], a[0:3]
v_mfma_f32_16x16x32_bf16 a[32:35], v[192:195], a[148:151], a[32:35]
v_mfma_f32_16x16x32_bf16 a[64:67], v[192:195], a[152:155], a[64:67]
v_mfma_f32_16x16x32_bf16 a[4:7], v[196:199], a[144:147], a[4:7]
v_mfma_f32_16x16x32_bf16 a[36:39], v[196:199], a[148:151], a[36:39]
v_mfma_f32_16x16x32_bf16 a[68:71], v[196:199], a[152:155], a[68:71]
v_mfma_f32_16x16x32_bf16 a[8:11], v[200:203], a[144:147], a[8:11]
v_mfma_f32_16x16x32_bf16 a[40:43], v[200:203], a[148:151], a[40:43]
v_mfma_f32_16x16x32_bf16 a[72:75], v[200:203], a[152:155], a[72:75]
v_mfma_f32_16x16x32_bf16 a[12:15], v[204:207], a[144:147], a[12:15]
v_mfma_f32_16x16x32_bf16 a[44:47], v[204:207], a[148:151], a[44:47]
v_mfma_f32_16x16x32_bf16 a[76:79], v[204:207], a[152:155], a[76:79]
v_mfma_f32_16x16x32_bf16 a[16:19], v[208:211], a[144:147], a[16:19]
v_mfma_f32_16x16x32_bf16 a[48:51], v[208:211], a[148:151], a[48:51]
v_mfma_f32_16x16x32_bf16 a[80:83], v[208:211], a[152:155], a[80:83]
v_mfma_f32_16x16x32_bf16 a[20:23], v[212:215], a[144:147], a[20:23]
v_mfma_f32_16x16x32_bf16 a[52:55], v[212:215], a[148:151], a[52:55]
v_mfma_f32_16x16x32_bf16 a[84:87], v[212:215], a[152:155], a[84:87]
v_mfma_f32_16x16x32_bf16 a[24:27], v[216:219], a[144:147], a[24:27]
v_mfma_f32_16x16x32_bf16 a[56:59], v[216:219], a[148:151], a[56:59]
v_mfma_f32_16x16x32_bf16 a[88:91], v[216:219], a[152:155], a[88:91]
v_mfma_f32_16x16x32_bf16 a[28:31], v[220:223], a[144:147], a[28:31]
v_mfma_f32_16x16x32_bf16 a[60:63], v[220:223], a[148:151], a[60:63]
v_mfma_f32_16x16x32_bf16 a[92:95], v[220:223], a[152:155], a[92:95]
s_add_u32 s92, s75, 29
s_and_b32 s92, s92, 7
s_add_u32 s92, s92, 24
s_lshl_b32 s93, s92, 10
s_add_u32 s78, s72, s93
buffer_load_dwordx4 a[144:147], v5, s[44:47], s78 offen
buffer_load_dwordx4 a[148:151], v6, s[44:47], s78 offen
buffer_load_dwordx4 a[152:155], v7, s[44:47], s78 offen
s_mul_i32 s93, s92, 40960
s_add_u32 s79, s73, s93
buffer_load_dwordx4 v[160:163], v11, s[48:51], s79 offen
buffer_load_dwordx4 v[164:167], v11, s[48:51], s79 offen offset:1280
buffer_load_dwordx4 v[168:171], v11, s[48:51], s79 offen offset:2560
buffer_load_dwordx4 v[172:175], v11, s[48:51], s79 offen offset:3840
buffer_load_dwordx4 v[176:179], v12, s[48:51], s79 offen
buffer_load_dwordx4 v[180:183], v12, s[48:51], s79 offen offset:1280
buffer_load_dwordx4 v[184:187], v12, s[48:51], s79 offen offset:2560
buffer_load_dwordx4 v[188:191], v12, s[48:51], s79 offen offset:3840
s_waitcnt vmcnt(44)
v_perm_b32 v192, v36, v32, s11
v_perm_b32 v193, v44, v40, s11
v_perm_b32 v194, v52, v48, s11
v_perm_b32 v195, v60, v56, s11
v_perm_b32 v196, v36, v32, s12
v_perm_b32 v197, v44, v40, s12
v_perm_b32 v198, v52, v48, s12
v_perm_b32 v199, v60, v56, s12
v_perm_b32 v200, v37, v33, s11
v_perm_b32 v201, v45, v41, s11
v_perm_b32 v202, v53, v49, s11
v_perm_b32 v203, v61, v57, s11
v_perm_b32 v204, v37, v33, s12
v_perm_b32 v205, v45, v41, s12
v_perm_b32 v206, v53, v49, s12
v_perm_b32 v207, v61, v57, s12
v_perm_b32 v208, v38, v34, s11
v_perm_b32 v209, v46, v42, s11
v_perm_b32 v210, v54, v50, s11
v_perm_b32 v211, v62, v58, s11
v_perm_b32 v212, v38, v34, s12
v_perm_b32 v213, v46, v42, s12
v_perm_b32 v214, v54, v50, s12
v_perm_b32 v215, v62, v58, s12
v_perm_b32 v216, v39, v35, s11
v_perm_b32 v217, v47, v43, s11
v_perm_b32 v218, v55, v51, s11
v_perm_b32 v219, v63, v59, s11
v_perm_b32 v220, v39, v35, s12
v_perm_b32 v221, v47, v43, s12
v_perm_b32 v222, v55, v51, s12
v_perm_b32 v223, v63, v59, s12
v_mfma_f32_16x16x32_bf16 a[0:3], v[192:195], a[96:99], a[0:3]
v_mfma_f32_16x16x32_bf16 a[32:35], v[192:195], a[100:103], a[32:35]
v_mfma_f32_16x16x32_bf16 a[64:67], v[192:195], a[104:107], a[64:67]
v_mfma_f32_16x16x32_bf16 a[4:7], v[196:199], a[96:99], a[4:7]
v_mfma_f32_16x16x32_bf16 a[36:39], v[196:199], a[100:103], a[36:39]
v_mfma_f32_16x16x32_bf16 a[68:71], v[196:199], a[104:107], a[68:71]
v_mfma_f32_16x16x32_bf16 a[8:11], v[200:203], a[96:99], a[8:11]
v_mfma_f32_16x16x32_bf16 a[40:43], v[200:203], a[100:103], a[40:43]
v_mfma_f32_16x16x32_bf16 a[72:75], v[200:203], a[104:107], a[72:75]
v_mfma_f32_16x16x32_bf16 a[12:15], v[204:207], a[96:99], a[12:15]
v_mfma_f32_16x16x32_bf16 a[44:47], v[204:207], a[100:103], a[44:47]
v_mfma_f32_16x16x32_bf16 a[76:79], v[204:207], a[104:107], a[76:79]
v_mfma_f32_16x16x32_bf16 a[16:19], v[208:211], a[96:99], a[16:19]
v_mfma_f32_16x16x32_bf16 a[48:51], v[208:211], a[100:103], a[48:51]
v_mfma_f32_16x16x32_bf16 a[80:83], v[208:211], a[104:107], a[80:83]
v_mfma_f32_16x16x32_bf16 a[20:23], v[212:215], a[96:99], a[20:23]
v_mfma_f32_16x16x32_bf16 a[52:55], v[212:215], a[100:103], a[52:55]
v_mfma_f32_16x16x32_bf16 a[84:87], v[212:215], a[104:107], a[84:87]
v_mfma_f32_16x16x32_bf16 a[24:27], v[216:219], a[96:99], a[24:27]
v_mfma_f32_16x16x32_bf16 a[56:59], v[216:219], a[100:103], a[56:59]
v_mfma_f32_16x16x32_bf16 a[88:91], v[216:219], a[104:107], a[88:91]
v_mfma_f32_16x16x32_bf16 a[28:31], v[220:223], a[96:99], a[28:31]
v_mfma_f32_16x16x32_bf16 a[60:63], v[220:223], a[100:103], a[60:63]
v_mfma_f32_16x16x32_bf16 a[92:95], v[220:223], a[104:107], a[92:95]
s_add_u32 s92, s75, 30
s_and_b32 s92, s92, 7
s_add_u32 s92, s92, 24
s_lshl_b32 s93, s92, 10
s_add_u32 s80, s72, s93
buffer_load_dwordx4 a[96:99], v5, s[44:47], s80 offen
buffer_load_dwordx4 a[100:103], v6, s[44:47], s80 offen
buffer_load_dwordx4 a[104:107], v7, s[44:47], s80 offen
s_mul_i32 s93, s92, 40960
s_add_u32 s81, s73, s93
buffer_load_dwordx4 v[32:35], v11, s[48:51], s81 offen
buffer_load_dwordx4 v[36:39], v11, s[48:51], s81 offen offset:1280
buffer_load_dwordx4 v[40:43], v11, s[48:51], s81 offen offset:2560
buffer_load_dwordx4 v[44:47], v11, s[48:51], s81 offen offset:3840
buffer_load_dwordx4 v[48:51], v12, s[48:51], s81 offen
buffer_load_dwordx4 v[52:55], v12, s[48:51], s81 offen offset:1280
buffer_load_dwordx4 v[56:59], v12, s[48:51], s81 offen offset:2560
buffer_load_dwordx4 v[60:63], v12, s[48:51], s81 offen offset:3840
s_waitcnt vmcnt(44)
v_perm_b32 v192, v68, v64, s11
v_perm_b32 v193, v76, v72, s11
v_perm_b32 v194, v84, v80, s11
v_perm_b32 v195, v92, v88, s11
v_perm_b32 v196, v68, v64, s12
v_perm_b32 v197, v76, v72, s12
v_perm_b32 v198, v84, v80, s12
v_perm_b32 v199, v92, v88, s12
v_perm_b32 v200, v69, v65, s11
v_perm_b32 v201, v77, v73, s11
v_perm_b32 v202, v85, v81, s11
v_perm_b32 v203, v93, v89, s11
v_perm_b32 v204, v69, v65, s12
v_perm_b32 v205, v77, v73, s12
v_perm_b32 v206, v85, v81, s12
v_perm_b32 v207, v93, v89, s12
v_perm_b32 v208, v70, v66, s11
v_perm_b32 v209, v78, v74, s11
v_perm_b32 v210, v86, v82, s11
v_perm_b32 v211, v94, v90, s11
v_perm_b32 v212, v70, v66, s12
v_perm_b32 v213, v78, v74, s12
v_perm_b32 v214, v86, v82, s12
v_perm_b32 v215, v94, v90, s12
v_perm_b32 v216, v71, v67, s11
v_perm_b32 v217, v79, v75, s11
v_perm_b32 v218, v87, v83, s11
v_perm_b32 v219, v95, v91, s11
v_perm_b32 v220, v71, v67, s12
v_perm_b32 v221, v79, v75, s12
v_perm_b32 v222, v87, v83, s12
v_perm_b32 v223, v95, v91, s12
v_mfma_f32_16x16x32_bf16 a[0:3], v[192:195], a[108:111], a[0:3]
v_mfma_f32_16x16x32_bf16 a[32:35], v[192:195], a[112:115], a[32:35]
v_mfma_f32_16x16x32_bf16 a[64:67], v[192:195], a[116:119], a[64:67]
v_mfma_f32_16x16x32_bf16 a[4:7], v[196:199], a[108:111], a[4:7]
v_mfma_f32_16x16x32_bf16 a[36:39], v[196:199], a[112:115], a[36:39]
v_mfma_f32_16x16x32_bf16 a[68:71], v[196:199], a[116:119], a[68:71]
v_mfma_f32_16x16x32_bf16 a[8:11], v[200:203], a[108:111], a[8:11]
v_mfma_f32_16x16x32_bf16 a[40:43], v[200:203], a[112:115], a[40:43]
v_mfma_f32_16x16x32_bf16 a[72:75], v[200:203], a[116:119], a[72:75]
v_mfma_f32_16x16x32_bf16 a[12:15], v[204:207], a[108:111], a[12:15]
v_mfma_f32_16x16x32_bf16 a[44:47], v[204:207], a[112:115], a[44:47]
v_mfma_f32_16x16x32_bf16 a[76:79], v[204:207], a[116:119], a[76:79]
v_mfma_f32_16x16x32_bf16 a[16:19], v[208:211], a[108:111], a[16:19]
v_mfma_f32_16x16x32_bf16 a[48:51], v[208:211], a[112:115], a[48:51]
v_mfma_f32_16x16x32_bf16 a[80:83], v[208:211], a[116:119], a[80:83]
v_mfma_f32_16x16x32_bf16 a[20:23], v[212:215], a[108:111], a[20:23]
v_mfma_f32_16x16x32_bf16 a[52:55], v[212:215], a[112:115], a[52:55]
v_mfma_f32_16x16x32_bf16 a[84:87], v[212:215], a[116:119], a[84:87]
v_mfma_f32_16x16x32_bf16 a[24:27], v[216:219], a[108:111], a[24:27]
v_mfma_f32_16x16x32_bf16 a[56:59], v[216:219], a[112:115], a[56:59]
v_mfma_f32_16x16x32_bf16 a[88:91], v[216:219], a[116:119], a[88:91]
v_mfma_f32_16x16x32_bf16 a[28:31], v[220:223], a[108:111], a[28:31]
v_mfma_f32_16x16x32_bf16 a[60:63], v[220:223], a[112:115], a[60:63]
v_mfma_f32_16x16x32_bf16 a[92:95], v[220:223], a[116:119], a[92:95]
s_add_u32 s92, s75, 31
s_and_b32 s92, s92, 7
s_add_u32 s92, s92, 24
s_lshl_b32 s93, s92, 10
s_add_u32 s82, s72, s93
buffer_load_dwordx4 a[108:111], v5, s[44:47], s82 offen
buffer_load_dwordx4 a[112:115], v6, s[44:47], s82 offen
buffer_load_dwordx4 a[116:119], v7, s[44:47], s82 offen
s_mul_i32 s93, s92, 40960
s_add_u32 s83, s73, s93
buffer_load_dwordx4 v[64:67], v11, s[48:51], s83 offen
buffer_load_dwordx4 v[68:71], v11, s[48:51], s83 offen offset:1280
buffer_load_dwordx4 v[72:75], v11, s[48:51], s83 offen offset:2560
buffer_load_dwordx4 v[76:79], v11, s[48:51], s83 offen offset:3840
buffer_load_dwordx4 v[80:83], v12, s[48:51], s83 offen
buffer_load_dwordx4 v[84:87], v12, s[48:51], s83 offen offset:1280
buffer_load_dwordx4 v[88:91], v12, s[48:51], s83 offen offset:2560
buffer_load_dwordx4 v[92:95], v12, s[48:51], s83 offen offset:3840
s_waitcnt vmcnt(44)
v_perm_b32 v192, v100, v96, s11
v_perm_b32 v193, v108, v104, s11
v_perm_b32 v194, v116, v112, s11
v_perm_b32 v195, v124, v120, s11
v_perm_b32 v196, v100, v96, s12
v_perm_b32 v197, v108, v104, s12
v_perm_b32 v198, v116, v112, s12
v_perm_b32 v199, v124, v120, s12
v_perm_b32 v200, v101, v97, s11
v_perm_b32 v201, v109, v105, s11
v_perm_b32 v202, v117, v113, s11
v_perm_b32 v203, v125, v121, s11
v_perm_b32 v204, v101, v97, s12
v_perm_b32 v205, v109, v105, s12
v_perm_b32 v206, v117, v113, s12
v_perm_b32 v207, v125, v121, s12
v_perm_b32 v208, v102, v98, s11
v_perm_b32 v209, v110, v106, s11
v_perm_b32 v210, v118, v114, s11
v_perm_b32 v211, v126, v122, s11
v_perm_b32 v212, v102, v98, s12
v_perm_b32 v213, v110, v106, s12
v_perm_b32 v214, v118, v114, s12
v_perm_b32 v215, v126, v122, s12
v_perm_b32 v216, v103, v99, s11
v_perm_b32 v217, v111, v107, s11
v_perm_b32 v218, v119, v115, s11
v_perm_b32 v219, v127, v123, s11
v_perm_b32 v220, v103, v99, s12
v_perm_b32 v221, v111, v107, s12
v_perm_b32 v222, v119, v115, s12
v_perm_b32 v223, v127, v123, s12
v_mfma_f32_16x16x32_bf16 a[0:3], v[192:195], a[120:123], a[0:3]
v_mfma_f32_16x16x32_bf16 a[32:35], v[192:195], a[124:127], a[32:35]
v_mfma_f32_16x16x32_bf16 a[64:67], v[192:195], a[128:131], a[64:67]
v_mfma_f32_16x16x32_bf16 a[4:7], v[196:199], a[120:123], a[4:7]
v_mfma_f32_16x16x32_bf16 a[36:39], v[196:199], a[124:127], a[36:39]
v_mfma_f32_16x16x32_bf16 a[68:71], v[196:199], a[128:131], a[68:71]
v_mfma_f32_16x16x32_bf16 a[8:11], v[200:203], a[120:123], a[8:11]
v_mfma_f32_16x16x32_bf16 a[40:43], v[200:203], a[124:127], a[40:43]
v_mfma_f32_16x16x32_bf16 a[72:75], v[200:203], a[128:131], a[72:75]
v_mfma_f32_16x16x32_bf16 a[12:15], v[204:207], a[120:123], a[12:15]
v_mfma_f32_16x16x32_bf16 a[44:47], v[204:207], a[124:127], a[44:47]
v_mfma_f32_16x16x32_bf16 a[76:79], v[204:207], a[128:131], a[76:79]
v_mfma_f32_16x16x32_bf16 a[16:19], v[208:211], a[120:123], a[16:19]
v_mfma_f32_16x16x32_bf16 a[48:51], v[208:211], a[124:127], a[48:51]
v_mfma_f32_16x16x32_bf16 a[80:83], v[208:211], a[128:131], a[80:83]
v_mfma_f32_16x16x32_bf16 a[20:23], v[212:215], a[120:123], a[20:23]
v_mfma_f32_16x16x32_bf16 a[52:55], v[212:215], a[124:127], a[52:55]
v_mfma_f32_16x16x32_bf16 a[84:87], v[212:215], a[128:131], a[84:87]
v_mfma_f32_16x16x32_bf16 a[24:27], v[216:219], a[120:123], a[24:27]
v_mfma_f32_16x16x32_bf16 a[56:59], v[216:219], a[124:127], a[56:59]
v_mfma_f32_16x16x32_bf16 a[88:91], v[216:219], a[128:131], a[88:91]
v_mfma_f32_16x16x32_bf16 a[28:31], v[220:223], a[120:123], a[28:31]
v_mfma_f32_16x16x32_bf16 a[60:63], v[220:223], a[124:127], a[60:63]
v_mfma_f32_16x16x32_bf16 a[92:95], v[220:223], a[128:131], a[92:95]
s_waitcnt vmcnt(33)
v_perm_b32 v192, v132, v128, s11
v_perm_b32 v193, v140, v136, s11
v_perm_b32 v194, v148, v144, s11
v_perm_b32 v195, v156, v152, s11
v_perm_b32 v196, v132, v128, s12
v_perm_b32 v197, v140, v136, s12
v_perm_b32 v198, v148, v144, s12
v_perm_b32 v199, v156, v152, s12
v_perm_b32 v200, v133, v129, s11
v_perm_b32 v201, v141, v137, s11
v_perm_b32 v202, v149, v145, s11
v_perm_b32 v203, v157, v153, s11
v_perm_b32 v204, v133, v129, s12
v_perm_b32 v205, v141, v137, s12
v_perm_b32 v206, v149, v145, s12
v_perm_b32 v207, v157, v153, s12
v_perm_b32 v208, v134, v130, s11
v_perm_b32 v209, v142, v138, s11
v_perm_b32 v210, v150, v146, s11
v_perm_b32 v211, v158, v154, s11
v_perm_b32 v212, v134, v130, s12
v_perm_b32 v213, v142, v138, s12
v_perm_b32 v214, v150, v146, s12
v_perm_b32 v215, v158, v154, s12
v_perm_b32 v216, v135, v131, s11
v_perm_b32 v217, v143, v139, s11
v_perm_b32 v218, v151, v147, s11
v_perm_b32 v219, v159, v155, s11
v_perm_b32 v220, v135, v131, s12
v_perm_b32 v221, v143, v139, s12
v_perm_b32 v222, v151, v147, s12
v_perm_b32 v223, v159, v155, s12
v_mfma_f32_16x16x32_bf16 a[0:3], v[192:195], a[132:135], a[0:3]
v_mfma_f32_16x16x32_bf16 a[32:35], v[192:195], a[136:139], a[32:35]
v_mfma_f32_16x16x32_bf16 a[64:67], v[192:195], a[140:143], a[64:67]
v_mfma_f32_16x16x32_bf16 a[4:7], v[196:199], a[132:135], a[4:7]
v_mfma_f32_16x16x32_bf16 a[36:39], v[196:199], a[136:139], a[36:39]
v_mfma_f32_16x16x32_bf16 a[68:71], v[196:199], a[140:143], a[68:71]
v_mfma_f32_16x16x32_bf16 a[8:11], v[200:203], a[132:135], a[8:11]
v_mfma_f32_16x16x32_bf16 a[40:43], v[200:203], a[136:139], a[40:43]
v_mfma_f32_16x16x32_bf16 a[72:75], v[200:203], a[140:143], a[72:75]
v_mfma_f32_16x16x32_bf16 a[12:15], v[204:207], a[132:135], a[12:15]
v_mfma_f32_16x16x32_bf16 a[44:47], v[204:207], a[136:139], a[44:47]
v_mfma_f32_16x16x32_bf16 a[76:79], v[204:207], a[140:143], a[76:79]
v_mfma_f32_16x16x32_bf16 a[16:19], v[208:211], a[132:135], a[16:19]
v_mfma_f32_16x16x32_bf16 a[48:51], v[208:211], a[136:139], a[48:51]
v_mfma_f32_16x16x32_bf16 a[80:83], v[208:211], a[140:143], a[80:83]
v_mfma_f32_16x16x32_bf16 a[20:23], v[212:215], a[132:135], a[20:23]
v_mfma_f32_16x16x32_bf16 a[52:55], v[212:215], a[136:139], a[52:55]
v_mfma_f32_16x16x32_bf16 a[84:87], v[212:215], a[140:143], a[84:87]
v_mfma_f32_16x16x32_bf16 a[24:27], v[216:219], a[132:135], a[24:27]
v_mfma_f32_16x16x32_bf16 a[56:59], v[216:219], a[136:139], a[56:59]
v_mfma_f32_16x16x32_bf16 a[88:91], v[216:219], a[140:143], a[88:91]
v_mfma_f32_16x16x32_bf16 a[28:31], v[220:223], a[132:135], a[28:31]
v_mfma_f32_16x16x32_bf16 a[60:63], v[220:223], a[136:139], a[60:63]
v_mfma_f32_16x16x32_bf16 a[92:95], v[220:223], a[140:143], a[92:95]
s_waitcnt vmcnt(22)
v_perm_b32 v192, v164, v160, s11
v_perm_b32 v193, v172, v168, s11
v_perm_b32 v194, v180, v176, s11
v_perm_b32 v195, v188, v184, s11
v_perm_b32 v196, v164, v160, s12
v_perm_b32 v197, v172, v168, s12
v_perm_b32 v198, v180, v176, s12
v_perm_b32 v199, v188, v184, s12
v_perm_b32 v200, v165, v161, s11
v_perm_b32 v201, v173, v169, s11
v_perm_b32 v202, v181, v177, s11
v_perm_b32 v203, v189, v185, s11
v_perm_b32 v204, v165, v161, s12
v_perm_b32 v205, v173, v169, s12
v_perm_b32 v206, v181, v177, s12
v_perm_b32 v207, v189, v185, s12
v_perm_b32 v208, v166, v162, s11
v_perm_b32 v209, v174, v170, s11
v_perm_b32 v210, v182, v178, s11
v_perm_b32 v211, v190, v186, s11
v_perm_b32 v212, v166, v162, s12
v_perm_b32 v213, v174, v170, s12
v_perm_b32 v214, v182, v178, s12
v_perm_b32 v215, v190, v186, s12
v_perm_b32 v216, v167, v163, s11
v_perm_b32 v217, v175, v171, s11
v_perm_b32 v218, v183, v179, s11
v_perm_b32 v219, v191, v187, s11
v_perm_b32 v220, v167, v163, s12
v_perm_b32 v221, v175, v171, s12
v_perm_b32 v222, v183, v179, s12
v_perm_b32 v223, v191, v187, s12
v_mfma_f32_16x16x32_bf16 a[0:3], v[192:195], a[144:147], a[0:3]
v_mfma_f32_16x16x32_bf16 a[32:35], v[192:195], a[148:151], a[32:35]
v_mfma_f32_16x16x32_bf16 a[64:67], v[192:195], a[152:155], a[64:67]
v_mfma_f32_16x16x32_bf16 a[4:7], v[196:199], a[144:147], a[4:7]
v_mfma_f32_16x16x32_bf16 a[36:39], v[196:199], a[148:151], a[36:39]
v_mfma_f32_16x16x32_bf16 a[68:71], v[196:199], a[152:155], a[68:71]
v_mfma_f32_16x16x32_bf16 a[8:11], v[200:203], a[144:147], a[8:11]
v_mfma_f32_16x16x32_bf16 a[40:43], v[200:203], a[148:151], a[40:43]
v_mfma_f32_16x16x32_bf16 a[72:75], v[200:203], a[152:155], a[72:75]
v_mfma_f32_16x16x32_bf16 a[12:15], v[204:207], a[144:147], a[12:15]
v_mfma_f32_16x16x32_bf16 a[44:47], v[204:207], a[148:151], a[44:47]
v_mfma_f32_16x16x32_bf16 a[76:79], v[204:207], a[152:155], a[76:79]
v_mfma_f32_16x16x32_bf16 a[16:19], v[208:211], a[144:147], a[16:19]
v_mfma_f32_16x16x32_bf16 a[48:51], v[208:211], a[148:151], a[48:51]
v_mfma_f32_16x16x32_bf16 a[80:83], v[208:211], a[152:155], a[80:83]
v_mfma_f32_16x16x32_bf16 a[20:23], v[212:215], a[144:147], a[20:23]
v_mfma_f32_16x16x32_bf16 a[52:55], v[212:215], a[148:151], a[52:55]
v_mfma_f32_16x16x32_bf16 a[84:87], v[212:215], a[152:155], a[84:87]
v_mfma_f32_16x16x32_bf16 a[24:27], v[216:219], a[144:147], a[24:27]
v_mfma_f32_16x16x32_bf16 a[56:59], v[216:219], a[148:151], a[56:59]
v_mfma_f32_16x16x32_bf16 a[88:91], v[216:219], a[152:155], a[88:91]
v_mfma_f32_16x16x32_bf16 a[28:31], v[220:223], a[144:147], a[28:31]
v_mfma_f32_16x16x32_bf16 a[60:63], v[220:223], a[148:151], a[60:63]
v_mfma_f32_16x16x32_bf16 a[92:95], v[220:223], a[152:155], a[92:95]
s_waitcnt vmcnt(11)
v_perm_b32 v192, v36, v32, s11
v_perm_b32 v193, v44, v40, s11
v_perm_b32 v194, v52, v48, s11
v_perm_b32 v195, v60, v56, s11
v_perm_b32 v196, v36, v32, s12
v_perm_b32 v197, v44, v40, s12
v_perm_b32 v198, v52, v48, s12
v_perm_b32 v199, v60, v56, s12
v_perm_b32 v200, v37, v33, s11
v_perm_b32 v201, v45, v41, s11
v_perm_b32 v202, v53, v49, s11
v_perm_b32 v203, v61, v57, s11
v_perm_b32 v204, v37, v33, s12
v_perm_b32 v205, v45, v41, s12
v_perm_b32 v206, v53, v49, s12
v_perm_b32 v207, v61, v57, s12
v_perm_b32 v208, v38, v34, s11
v_perm_b32 v209, v46, v42, s11
v_perm_b32 v210, v54, v50, s11
v_perm_b32 v211, v62, v58, s11
v_perm_b32 v212, v38, v34, s12
v_perm_b32 v213, v46, v42, s12
v_perm_b32 v214, v54, v50, s12
v_perm_b32 v215, v62, v58, s12
v_perm_b32 v216, v39, v35, s11
v_perm_b32 v217, v47, v43, s11
v_perm_b32 v218, v55, v51, s11
v_perm_b32 v219, v63, v59, s11
v_perm_b32 v220, v39, v35, s12
v_perm_b32 v221, v47, v43, s12
v_perm_b32 v222, v55, v51, s12
v_perm_b32 v223, v63, v59, s12
v_mfma_f32_16x16x32_bf16 a[0:3], v[192:195], a[96:99], a[0:3]
v_mfma_f32_16x16x32_bf16 a[32:35], v[192:195], a[100:103], a[32:35]
v_mfma_f32_16x16x32_bf16 a[64:67], v[192:195], a[104:107], a[64:67]
v_mfma_f32_16x16x32_bf16 a[4:7], v[196:199], a[96:99], a[4:7]
v_mfma_f32_16x16x32_bf16 a[36:39], v[196:199], a[100:103], a[36:39]
v_mfma_f32_16x16x32_bf16 a[68:71], v[196:199], a[104:107], a[68:71]
v_mfma_f32_16x16x32_bf16 a[8:11], v[200:203], a[96:99], a[8:11]
v_mfma_f32_16x16x32_bf16 a[40:43], v[200:203], a[100:103], a[40:43]
v_mfma_f32_16x16x32_bf16 a[72:75], v[200:203], a[104:107], a[72:75]
v_mfma_f32_16x16x32_bf16 a[12:15], v[204:207], a[96:99], a[12:15]
v_mfma_f32_16x16x32_bf16 a[44:47], v[204:207], a[100:103], a[44:47]
v_mfma_f32_16x16x32_bf16 a[76:79], v[204:207], a[104:107], a[76:79]
v_mfma_f32_16x16x32_bf16 a[16:19], v[208:211], a[96:99], a[16:19]
v_mfma_f32_16x16x32_bf16 a[48:51], v[208:211], a[100:103], a[48:51]
v_mfma_f32_16x16x32_bf16 a[80:83], v[208:211], a[104:107], a[80:83]
v_mfma_f32_16x16x32_bf16 a[20:23], v[212:215], a[96:99], a[20:23]
v_mfma_f32_16x16x32_bf16 a[52:55], v[212:215], a[100:103], a[52:55]
v_mfma_f32_16x16x32_bf16 a[84:87], v[212:215], a[104:107], a[84:87]
v_mfma_f32_16x16x32_bf16 a[24:27], v[216:219], a[96:99], a[24:27]
v_mfma_f32_16x16x32_bf16 a[56:59], v[216:219], a[100:103], a[56:59]
v_mfma_f32_16x16x32_bf16 a[88:91], v[216:219], a[104:107], a[88:91]
v_mfma_f32_16x16x32_bf16 a[28:31], v[220:223], a[96:99], a[28:31]
v_mfma_f32_16x16x32_bf16 a[60:63], v[220:223], a[100:103], a[60:63]
v_mfma_f32_16x16x32_bf16 a[92:95], v[220:223], a[104:107], a[92:95]
s_waitcnt vmcnt(0)
v_perm_b32 v192, v68, v64, s11
v_perm_b32 v193, v76, v72, s11
v_perm_b32 v194, v84, v80, s11
v_perm_b32 v195, v92, v88, s11
v_perm_b32 v196, v68, v64, s12
v_perm_b32 v197, v76, v72, s12
v_perm_b32 v198, v84, v80, s12
v_perm_b32 v199, v92, v88, s12
v_perm_b32 v200, v69, v65, s11
v_perm_b32 v201, v77, v73, s11
v_perm_b32 v202, v85, v81, s11
v_perm_b32 v203, v93, v89, s11
v_perm_b32 v204, v69, v65, s12
v_perm_b32 v205, v77, v73, s12
v_perm_b32 v206, v85, v81, s12
v_perm_b32 v207, v93, v89, s12
v_perm_b32 v208, v70, v66, s11
v_perm_b32 v209, v78, v74, s11
v_perm_b32 v210, v86, v82, s11
v_perm_b32 v211, v94, v90, s11
v_perm_b32 v212, v70, v66, s12
v_perm_b32 v213, v78, v74, s12
v_perm_b32 v214, v86, v82, s12
v_perm_b32 v215, v94, v90, s12
v_perm_b32 v216, v71, v67, s11
v_perm_b32 v217, v79, v75, s11
v_perm_b32 v218, v87, v83, s11
v_perm_b32 v219, v95, v91, s11
v_perm_b32 v220, v71, v67, s12
v_perm_b32 v221, v79, v75, s12
v_perm_b32 v222, v87, v83, s12
v_perm_b32 v223, v95, v91, s12
v_mfma_f32_16x16x32_bf16 a[0:3], v[192:195], a[108:111], a[0:3]
v_mfma_f32_16x16x32_bf16 a[32:35], v[192:195], a[112:115], a[32:35]
v_mfma_f32_16x16x32_bf16 a[64:67], v[192:195], a[116:119], a[64:67]
v_mfma_f32_16x16x32_bf16 a[4:7], v[196:199], a[108:111], a[4:7]
v_mfma_f32_16x16x32_bf16 a[36:39], v[196:199], a[112:115], a[36:39]
v_mfma_f32_16x16x32_bf16 a[68:71], v[196:199], a[116:119], a[68:71]
v_mfma_f32_16x16x32_bf16 a[8:11], v[200:203], a[108:111], a[8:11]
v_mfma_f32_16x16x32_bf16 a[40:43], v[200:203], a[112:115], a[40:43]
v_mfma_f32_16x16x32_bf16 a[72:75], v[200:203], a[116:119], a[72:75]
v_mfma_f32_16x16x32_bf16 a[12:15], v[204:207], a[108:111], a[12:15]
v_mfma_f32_16x16x32_bf16 a[44:47], v[204:207], a[112:115], a[44:47]
v_mfma_f32_16x16x32_bf16 a[76:79], v[204:207], a[116:119], a[76:79]
v_mfma_f32_16x16x32_bf16 a[16:19], v[208:211], a[108:111], a[16:19]
v_mfma_f32_16x16x32_bf16 a[48:51], v[208:211], a[112:115], a[48:51]
v_mfma_f32_16x16x32_bf16 a[80:83], v[208:211], a[116:119], a[80:83]
v_mfma_f32_16x16x32_bf16 a[20:23], v[212:215], a[108:111], a[20:23]
v_mfma_f32_16x16x32_bf16 a[52:55], v[212:215], a[112:115], a[52:55]
v_mfma_f32_16x16x32_bf16 a[84:87], v[212:215], a[116:119], a[84:87]
v_mfma_f32_16x16x32_bf16 a[24:27], v[216:219], a[108:111], a[24:27]
v_mfma_f32_16x16x32_bf16 a[56:59], v[216:219], a[112:115], a[56:59]
v_mfma_f32_16x16x32_bf16 a[88:91], v[216:219], a[116:119], a[88:91]
v_mfma_f32_16x16x32_bf16 a[28:31], v[220:223], a[108:111], a[28:31]
v_mfma_f32_16x16x32_bf16 a[60:63], v[220:223], a[112:115], a[60:63]
v_mfma_f32_16x16x32_bf16 a[92:95], v[220:223], a[116:119], a[92:95]
ds_write_b128 v18, a[0:3]
ds_write_b128 v18, a[4:7] offset:1024
ds_write_b128 v18, a[8:11] offset:2048
ds_write_b128 v18, a[12:15] offset:3072
ds_write_b128 v18, a[16:19] offset:4096
ds_write_b128 v18, a[20:23] offset:5120
ds_write_b128 v18, a[24:27] offset:6144
ds_write_b128 v18, a[28:31] offset:7168
ds_write_b128 v18, a[32:35] offset:8192
ds_write_b128 v18, a[36:39] offset:9216
ds_write_b128 v18, a[40:43] offset:10240
ds_write_b128 v18, a[44:47] offset:11264
ds_write_b128 v18, a[48:51] offset:12288
ds_write_b128 v18, a[52:55] offset:13312
ds_write_b128 v18, a[56:59] offset:14336
ds_write_b128 v18, a[60:63] offset:15360
ds_write_b128 v18, a[64:67] offset:16384
ds_write_b128 v18, a[68:71] offset:17408
ds_write_b128 v18, a[72:75] offset:18432
ds_write_b128 v18, a[76:79] offset:19456
ds_write_b128 v18, a[80:83] offset:20480
ds_write_b128 v18, a[84:87] offset:21504
ds_write_b128 v18, a[88:91] offset:22528
ds_write_b128 v18, a[92:95] offset:23552
s_waitcnt lgkmcnt(0)
s_barrier
s_cmp_ge_u32 s3, 3
s_cbranch_scc1 L_oproj_end
ds_read_b128 v[32:35], v19
ds_read_b128 v[36:39], v19 offset:1024
ds_read_b128 v[40:43], v19 offset:2048
ds_read_b128 v[44:47], v19 offset:3072
ds_read_b128 v[48:51], v19 offset:4096
ds_read_b128 v[52:55], v19 offset:5120
ds_read_b128 v[56:59], v19 offset:6144
ds_read_b128 v[60:63], v19 offset:7168
ds_read_b128 v[64:67], v19 offset:24576
ds_read_b128 v[68:71], v19 offset:25600
ds_read_b128 v[72:75], v19 offset:26624
ds_read_b128 v[76:79], v19 offset:27648
ds_read_b128 v[80:83], v19 offset:28672
ds_read_b128 v[84:87], v19 offset:29696
ds_read_b128 v[88:91], v19 offset:30720
ds_read_b128 v[92:95], v19 offset:31744
ds_read_b128 v[96:99], v21
ds_read_b128 v[100:103], v21 offset:1024
ds_read_b128 v[104:107], v21 offset:2048
ds_read_b128 v[108:111], v21 offset:3072
ds_read_b128 v[112:115], v21 offset:4096
ds_read_b128 v[116:119], v21 offset:5120
ds_read_b128 v[120:123], v21 offset:6144
ds_read_b128 v[124:127], v21 offset:7168
ds_read_b128 v[128:131], v21 offset:24576
ds_read_b128 v[132:135], v21 offset:25600
ds_read_b128 v[136:139], v21 offset:26624
ds_read_b128 v[140:143], v21 offset:27648
ds_read_b128 v[144:147], v21 offset:28672
ds_read_b128 v[148:151], v21 offset:29696
ds_read_b128 v[152:155], v21 offset:30720
ds_read_b128 v[156:159], v21 offset:31744
s_waitcnt lgkmcnt(0)
v_add_f32 v32, v32, v64
v_add_f32 v32, v32, v96
v_add_f32 v32, v32, v128
v_add_f32 v33, v33, v65
v_add_f32 v33, v33, v97
v_add_f32 v33, v33, v129
v_add_f32 v34, v34, v66
v_add_f32 v34, v34, v98
v_add_f32 v34, v34, v130
v_add_f32 v35, v35, v67
v_add_f32 v35, v35, v99
v_add_f32 v35, v35, v131
v_add_f32 v36, v36, v68
v_add_f32 v36, v36, v100
v_add_f32 v36, v36, v132
v_add_f32 v37, v37, v69
v_add_f32 v37, v37, v101
v_add_f32 v37, v37, v133
v_add_f32 v38, v38, v70
v_add_f32 v38, v38, v102
v_add_f32 v38, v38, v134
v_add_f32 v39, v39, v71
v_add_f32 v39, v39, v103
v_add_f32 v39, v39, v135
v_add_f32 v40, v40, v72
v_add_f32 v40, v40, v104
v_add_f32 v40, v40, v136
v_add_f32 v41, v41, v73
v_add_f32 v41, v41, v105
v_add_f32 v41, v41, v137
v_add_f32 v42, v42, v74
v_add_f32 v42, v42, v106
v_add_f32 v42, v42, v138
v_add_f32 v43, v43, v75
v_add_f32 v43, v43, v107
v_add_f32 v43, v43, v139
v_add_f32 v44, v44, v76
v_add_f32 v44, v44, v108
v_add_f32 v44, v44, v140
v_add_f32 v45, v45, v77
v_add_f32 v45, v45, v109
v_add_f32 v45, v45, v141
v_add_f32 v46, v46, v78
v_add_f32 v46, v46, v110
v_add_f32 v46, v46, v142
v_add_f32 v47, v47, v79
v_add_f32 v47, v47, v111
v_add_f32 v47, v47, v143
v_add_f32 v48, v48, v80
v_add_f32 v48, v48, v112
v_add_f32 v48, v48, v144
v_add_f32 v49, v49, v81
v_add_f32 v49, v49, v113
v_add_f32 v49, v49, v145
v_add_f32 v50, v50, v82
v_add_f32 v50, v50, v114
v_add_f32 v50, v50, v146
v_add_f32 v51, v51, v83
v_add_f32 v51, v51, v115
v_add_f32 v51, v51, v147
v_add_f32 v52, v52, v84
v_add_f32 v52, v52, v116
v_add_f32 v52, v52, v148
v_add_f32 v53, v53, v85
v_add_f32 v53, v53, v117
v_add_f32 v53, v53, v149
v_add_f32 v54, v54, v86
v_add_f32 v54, v54, v118
v_add_f32 v54, v54, v150
v_add_f32 v55, v55, v87
v_add_f32 v55, v55, v119
v_add_f32 v55, v55, v151
v_add_f32 v56, v56, v88
v_add_f32 v56, v56, v120
v_add_f32 v56, v56, v152
v_add_f32 v57, v57, v89
v_add_f32 v57, v57, v121
v_add_f32 v57, v57, v153
v_add_f32 v58, v58, v90
v_add_f32 v58, v58, v122
v_add_f32 v58, v58, v154
v_add_f32 v59, v59, v91
v_add_f32 v59, v59, v123
v_add_f32 v59, v59, v155
v_add_f32 v60, v60, v92
v_add_f32 v60, v60, v124
v_add_f32 v60, v60, v156
v_add_f32 v61, v61, v93
v_add_f32 v61, v61, v125
v_add_f32 v61, v61, v157
v_add_f32 v62, v62, v94
v_add_f32 v62, v62, v126
v_add_f32 v62, v62, v158
v_add_f32 v63, v63, v95
v_add_f32 v63, v63, v127
v_add_f32 v63, v63, v159
v_cvt_pk_bf16_f32 v160, v32, v36
v_cvt_pk_bf16_f32 v161, v40, v44
v_cvt_pk_bf16_f32 v162, v48, v52
v_cvt_pk_bf16_f32 v163, v56, v60
v_cvt_pk_bf16_f32 v164, v33, v37
v_cvt_pk_bf16_f32 v165, v41, v45
v_cvt_pk_bf16_f32 v166, v49, v53
v_cvt_pk_bf16_f32 v167, v57, v61
v_cvt_pk_bf16_f32 v168, v34, v38
v_cvt_pk_bf16_f32 v169, v42, v46
v_cvt_pk_bf16_f32 v170, v50, v54
v_cvt_pk_bf16_f32 v171, v58, v62
v_cvt_pk_bf16_f32 v172, v35, v39
v_cvt_pk_bf16_f32 v173, v43, v47
v_cvt_pk_bf16_f32 v174, v51, v55
v_cvt_pk_bf16_f32 v175, v59, v63
buffer_store_dwordx4 v[160:163], v20, s[52:55], s74 offen
buffer_store_dwordx4 v[164:167], v20, s[52:55], s74 offen offset:16
buffer_store_dwordx4 v[168:171], v20, s[52:55], s74 offen offset:32
buffer_store_dwordx4 v[172:175], v20, s[52:55], s74 offen offset:48
s_nop 7
s_nop 7
L_oproj_end:
s_endpgm
.section .rodata,"a"
.p2align 6
.amdhsa_kernel attn_kernel
  .amdhsa_next_free_vgpr 168
  .amdhsa_next_free_sgpr 100
  .amdhsa_accum_offset 168
  .amdhsa_group_segment_fixed_size 0
  .amdhsa_kernarg_size 104
  .amdhsa_user_sgpr_count 2
  .amdhsa_user_sgpr_kernarg_segment_ptr 1
  .amdhsa_system_sgpr_workgroup_id_x 1
.end_amdhsa_kernel
.p2align 6
.amdhsa_kernel oproj_kernel
  .amdhsa_next_free_vgpr 448
  .amdhsa_next_free_sgpr 100
  .amdhsa_accum_offset 256
  .amdhsa_group_segment_fixed_size 0
  .amdhsa_kernarg_size 104
  .amdhsa_user_sgpr_count 2
  .amdhsa_user_sgpr_kernarg_segment_ptr 1
  .amdhsa_system_sgpr_workgroup_id_x 1
.end_amdhsa_kernel
```
